```python
import torch

def _softmax(x, axis=-1):
    return torch.softmax(x, dim=axis)
def _gelu(x):
    return torch.nn.functional.gelu(x, approximate="tanh")
def _silu(x):
    return torch.nn.functional.silu(x)
def _sigmoid(x):
    return torch.sigmoid(x)
def _layernorm(x, axis=-1, eps=1e-5):
    m = x.mean(dim=axis, keepdim=True)
    v = x.var(dim=axis, keepdim=True, unbiased=False)
    return (x - m) / torch.sqrt(v + eps)
def _scatter_add(tgt, idx, src, axis=0):
    return tgt.clone().index_add_(axis, idx, src)
def _segment_sum(src, seg, n):
    out = torch.zeros((n,) + src.shape[1:], dtype=src.dtype)
    return out.index_add_(0, seg, src)
def _pad(x, pw):
    flat = tuple(v for pair in reversed(pw) for v in pair)
    return torch.nn.functional.pad(x, flat)

kernel_name = 'parallel_sum__ssm_conv_s4__glu_gated_reglu__prompt'

def setup_inputs():

    _w = (lambda a: (lambda t: t.to(torch.bfloat16) if t.is_floating_point() else t)(torch.as_tensor(a)))
    def _A_setup():
        B, L, D, N = 1, 2048, 640, 128
        A_re = -(lambda _x: torch.exp(torch.as_tensor(_x)))((lambda *s: torch.randn(*s, dtype=torch.bfloat16) * 6.4)(D, N))
        A_im = torch.pi * (lambda *s: torch.randn(*s, dtype=torch.bfloat16) * 0.05)(D, N)
        B_re = (lambda *s: torch.randn(*s, dtype=torch.bfloat16) * 0.1)(D, N)
        B_im = (lambda *s: torch.randn(*s, dtype=torch.bfloat16) * 0.1)(D, N)
        C_re = (lambda *s: torch.randn(*s, dtype=torch.bfloat16) * 0.1)(D, N)
        C_im = (lambda *s: torch.randn(*s, dtype=torch.bfloat16) * 0.1)(D, N)
        log_dt = (lambda *s: torch.randn(*s, dtype=torch.bfloat16) * 0.05)(D) * 0.5 - 4.0
        Dskip = (lambda *s: torch.randn(*s, dtype=torch.bfloat16) * 0.05)(D)
        return {
            "u": _w((lambda *s: torch.randn(*s, dtype=torch.bfloat16) * 0.05)(B, L, D)),
            "A_re": _w(A_re),
            "A_im": _w(A_im),
            "B_re": _w(B_re),
            "B_im": _w(B_im),
            "C_re": _w(C_re),
            "C_im": _w(C_im),
            "log_dt": _w(log_dt),
            "Dskip": _w(Dskip),
        }
    _A_in = _A_setup()

    def _B_setup():
        B, S, D, F = 1, 2048, 640, 1728
        return {
            "x": _w((lambda *s: torch.randn(*s, dtype=torch.bfloat16) * 0.05)(B, S, D)),
            "W_gate": _w((lambda *s: torch.randn(*s, dtype=torch.bfloat16) * 0.4)(D, F) * (2.0 / D) ** 0.5),
            "W_up": _w((lambda *s: torch.randn(*s, dtype=torch.bfloat16) * 0.4)(D, F) * (2.0 / D) ** 0.5),
            "W_down": _w((lambda *s: torch.randn(*s, dtype=torch.bfloat16) * 0.4)(F, D) * (1.0 / F) ** 0.5),
        }
    _B_in = _B_setup()

    return {
        "A_u": _A_in["u"],
        "A_A_re": _A_in["A_re"],
        "A_A_im": _A_in["A_im"],
        "A_B_re": _A_in["B_re"],
        "A_B_im": _A_in["B_im"],
        "A_C_re": _A_in["C_re"],
        "A_C_im": _A_in["C_im"],
        "A_log_dt": _A_in["log_dt"],
        "A_Dskip": _A_in["Dskip"],
        "B_x": _B_in["x"],
        "B_W_gate": _B_in["W_gate"],
        "B_W_up": _B_in["W_up"],
        "B_W_down": _B_in["W_down"],
    }

def reference(A_u, A_A_re, A_A_im, A_B_re, A_B_im, A_C_re, A_C_im, A_log_dt, A_Dskip, B_x, B_W_gate, B_W_up, B_W_down):
    def _A_ref(u, A_re, A_im, B_re, B_im, C_re, C_im, log_dt, Dskip):
        Bsz, L, D = u.shape
        dt = torch.exp(log_dt)[:, None]
        A = A_re + 1j * A_im
        Bc = B_re + 1j * B_im
        Cc = C_re + 1j * C_im
        logdA = dt * A
        dB = dt * Bc
        l = (lambda x, dt: x.to(dt))(torch.arange(L), A_re.dtype)
        P = torch.exp(logdA[:, :, None] * l[None, None, :])
        K = torch.einsum("dn,dnl,dn->dl", Cc, P, dB).real
        L2 = 2 * L
        Kp = _pad(K, ((0, 0), (0, L)))
        up = (lambda x, *d: x.permute(*d))(u, 0, 2, 1)
        up = _pad(up, ((0, 0), (0, 0), (0, L)))
        Kf = (lambda x, axes=(-2,-1): torch.fft.rfft2(x.float(), dim=axes))(Kp[:, None, :], axes=(-2, -1))
        Uf = (lambda x, axes=(-2,-1): torch.fft.rfft2(x.float(), dim=axes))(up[:, :, None, :], axes=(-2, -1))
        Yf = Uf * Kf[None, :, :, :]
        y = (lambda x, s, axes=(-2,-1): torch.fft.irfft2(x, s=s, dim=axes).to(torch.bfloat16))(Yf, (1, L2), axes=(-2, -1))[:, :, 0, :L]
        y = (lambda x, *d: x.permute(*d))(y, 0, 2, 1) + u * Dskip[None, None, :]
        return y

    def _B_ref(x, W_gate, W_up, W_down):
        gate = torch.einsum("bsd,df->bsf", x, W_gate)
        up = torch.einsum("bsd,df->bsf", x, W_up)
        gate = gate * (lambda x, dt: x.to(dt))(gate > 0, gate.dtype)
        h = gate * up
        return torch.einsum("bsf,fd->bsd", h, W_down)

    x = A_u
    xn = _layernorm(x, axis=-1)
    return x + _A_ref(xn, A_A_re, A_A_im, A_B_re, A_B_im, A_C_re, A_C_im, A_log_dt, A_Dskip) + _B_ref(xn, B_W_gate, B_W_up, B_W_down)
```

```asm
; @launch grid=(256,1,1) block=(512,1,1) lds=163840
.amdgcn_target "amdgcn-amd-amdhsa--gfx950"
.text
.globl parallel_sum__ssm_conv_s4__glu_gated_reglu__prompt_kernel
.p2align 8
.type parallel_sum__ssm_conv_s4__glu_gated_reglu__prompt_kernel,@function
parallel_sum__ssm_conv_s4__glu_gated_reglu__prompt_kernel:
    s_cmp_ge_u32 s2, 256
    s_cbranch_scc1 L_exit
    s_load_dwordx16 s[8:23], s[0:1], 0
    s_load_dwordx16 s[24:39], s[0:1], 64
    v_lshrrev_b32 v1, 6, v0
    v_and_b32 v0, 63, v0
    v_readfirstlane_b32 s56, v1
    s_and_b32 s67, s2, 7
    s_lshr_b32 s68, s2, 3
    s_and_b32 s58, s67, 1
    s_lshl_b32 s58, s58, 3
    s_and_b32 s69, s68, 7
    s_add_u32 s58, s58, s69
    s_lshr_b32 s62, s68, 3
    s_lshr_b32 s63, s67, 1
    s_mul_i32 s61, s63, 27
    s_mul_i32 s70, s62, 7
    s_add_u32 s61, s61, s70
    s_add_u32 s70, s62, s63
    s_and_b32 s70, s70, 3
    s_lshl_b32 s70, s70, 2
    s_lshr_b32 s64, 0x2332, s70
    s_and_b32 s64, s64, 15
    s_mul_i32 s65, s67, 80
    s_mul_i32 s69, s69, 10
    s_add_u32 s65, s65, s69
    s_lshr_b32 s70, 0x2740, s70
    s_and_b32 s70, s70, 15
    s_add_u32 s65, s65, s70
    s_and_b32 s59, s67, 1
    s_lshl_b32 s59, s59, 2
    s_add_u32 s59, s59, s63
    s_lshl_b32 s59, s59, 2
    s_and_b32 s70, s68, 3
    s_add_u32 s59, s59, s70
    s_lshr_b32 s60, s68, 2
    s_and_b32 s57, s56, 3
    s_lshl_b32 s70, s2, 3
    s_add_u32 s70, s70, s56
    s_mul_i32 s70, s70, 1280
    v_mul_u32_u24 v55, 20, v0
    v_add_u32 v54, s70, v55
    s_cmp_lt_u32 s56, 4
    s_cbranch_scc1 L_matrix
    s_cmp_gt_u32 s56, 4
    s_cbranch_scc1 L_worker
L_loader:
    s_mov_b32 s98, 1
    s_setprio 3
    s_mov_b32 s74, 4682
    s_lshl_b32 s71, s61, 5
    v_add_u32 v56, 0, v0
    v_mul_u32_u24 v57, s74, v56
    v_lshrrev_b32 v57, 16, v57
    v_mul_u32_u24 v58, 14, v57
    v_sub_u32 v58, v56, v58
    v_mul_u32_u24 v57, 3456, v57
    v_lshl_add_u32 v57, v58, 4, v57
    v_add_u32 v1, s71, v57
    v_add_u32 v56, 64, v0
    v_mul_u32_u24 v57, s74, v56
    v_lshrrev_b32 v57, 16, v57
    v_mul_u32_u24 v58, 14, v57
    v_sub_u32 v58, v56, v58
    v_mul_u32_u24 v57, 3456, v57
    v_lshl_add_u32 v57, v58, 4, v57
    v_add_u32 v2, s71, v57
    v_subrev_u32 v2, 1024, v2
    v_add_u32 v56, 128, v0
    v_mul_u32_u24 v57, s74, v56
    v_lshrrev_b32 v57, 16, v57
    v_mul_u32_u24 v58, 14, v57
    v_sub_u32 v58, v56, v58
    v_mul_u32_u24 v57, 3456, v57
    v_lshl_add_u32 v57, v58, 4, v57
    v_add_u32 v3, s71, v57
    v_subrev_u32 v3, 2048, v3
    v_add_u32 v56, 192, v0
    v_mul_u32_u24 v57, s74, v56
    v_lshrrev_b32 v57, 16, v57
    v_mul_u32_u24 v58, 14, v57
    v_sub_u32 v58, v56, v58
    v_mul_u32_u24 v57, 3456, v57
    v_lshl_add_u32 v57, v58, 4, v57
    v_add_u32 v4, s71, v57
    v_subrev_u32 v4, 3072, v4
    v_add_u32 v56, 256, v0
    v_mul_u32_u24 v57, s74, v56
    v_lshrrev_b32 v57, 16, v57
    v_mul_u32_u24 v58, 14, v57
    v_sub_u32 v58, v56, v58
    v_mul_u32_u24 v57, 3456, v57
    v_lshl_add_u32 v57, v58, 4, v57
    v_add_u32 v5, s71, v57
    v_add_u32 v56, 320, v0
    v_mul_u32_u24 v57, s74, v56
    v_lshrrev_b32 v57, 16, v57
    v_mul_u32_u24 v58, 14, v57
    v_sub_u32 v58, v56, v58
    v_mul_u32_u24 v57, 3456, v57
    v_lshl_add_u32 v57, v58, 4, v57
    v_add_u32 v6, s71, v57
    v_subrev_u32 v6, 1024, v6
    v_add_u32 v56, 384, v0
    v_mul_u32_u24 v57, s74, v56
    v_lshrrev_b32 v57, 16, v57
    v_mul_u32_u24 v58, 14, v57
    v_sub_u32 v58, v56, v58
    v_mul_u32_u24 v57, 3456, v57
    v_lshl_add_u32 v57, v58, 4, v57
    v_add_u32 v7, s71, v57
    v_subrev_u32 v7, 2048, v7
    v_lshrrev_b32 v56, 3, v0
    v_mul_u32_u24 v57, 1280, v56
    s_mul_i32 s70, s58, 163840
    v_add_u32 v57, s70, v57
    v_lshrrev_b32 v56, 4, v0
    v_xor_b32 v56, v56, v0
    v_and_b32 v56, 7, v56
    v_lshl_add_u32 v64, v56, 4, v57
    v_xor_b32 v56, 4, v56
    v_lshl_add_u32 v65, v56, 4, v57
    v_add_u32 v79, 150528, v65
    v_add_u32 v78, 141312, v64
    v_add_u32 v77, 132096, v65
    v_add_u32 v76, 122880, v64
    v_add_u32 v75, 109568, v65
    v_add_u32 v74, 100352, v64
    v_add_u32 v73, 91136, v65
    v_add_u32 v72, 81920, v64
    v_add_u32 v71, 68608, v65
    v_add_u32 v70, 59392, v64
    v_add_u32 v69, 50176, v65
    v_add_u32 v68, 40960, v64
    v_add_u32 v67, 27648, v65
    v_add_u32 v66, 18432, v64
    v_add_u32 v65, 9216, v65
    s_and_b32 s70, s58, 7
    s_mul_i32 s70, s70, 5
    s_lshr_b32 s70, s70, 2
    s_mul_i32 s71, s62, 5
    s_lshr_b32 s71, s71, 1
    s_add_u32 s70, s70, s71
    s_and_b32 s71, s2, 7
    s_lshl_b32 s71, s71, 2
    s_lshr_b32 s71, 0x0, s71
    s_and_b32 s71, s71, 15
    s_add_u32 s70, s70, s71
    s_cmp_ge_u32 s70, 10
    s_cselect_b32 s71, 10, 0
    s_sub_u32 s70, s70, s71
    s_mul_i32 s77, s70, 221184
    s_lshl_b32 s78, s70, 7
    s_waitcnt lgkmcnt(0)
    s_load_dword s66, s[38:39], 0
    s_mov_b32 s1, s56
    s_mov_b32 s44, s8
    s_and_b32 s45, s9, 0xffff
    s_mov_b32 s46, 2621440
    s_mov_b32 s47, 0x20000
    s_mov_b32 s48, s28
    s_and_b32 s49, s29, 0xffff
    s_mov_b32 s50, 2211840
    s_mov_b32 s51, 0x20000
    s_mov_b32 s52, s30
    s_and_b32 s53, s31, 0xffff
    s_mov_b32 s54, 2211840
    s_mov_b32 s55, 0x20000
    s_mov_b32 m0, 0
    s_nop 0
    buffer_load_dwordx4 v1, s[48:51], s77 offen offset:0 lds
    buffer_load_dwordx4 v2, s[48:51], s77 offen offset:1024 lds
    buffer_load_dwordx4 v3, s[48:51], s77 offen offset:2048 lds
    buffer_load_dwordx4 v4, s[48:51], s77 offen offset:3072 lds
    s_mov_b32 m0, 4096
    s_nop 0
    buffer_load_dwordx4 v5, s[48:51], s77 offen offset:0 lds
    buffer_load_dwordx4 v6, s[48:51], s77 offen offset:1024 lds
    buffer_load_dwordx4 v7, s[48:51], s77 offen offset:2048 lds
    s_mov_b32 m0, 58368
    s_nop 0
    buffer_load_dwordx4 v64, s[44:47], s78 offen offset:0 lds
    buffer_load_dwordx4 v65, s[44:47], s78 offen offset:1024 lds
    buffer_load_dwordx4 v66, s[44:47], s78 offen offset:2048 lds
    buffer_load_dwordx4 v67, s[44:47], s78 offen offset:3072 lds
    s_mov_b32 m0, 62464
    s_nop 0
    buffer_load_dwordx4 v68, s[44:47], s78 offen offset:0 lds
    buffer_load_dwordx4 v69, s[44:47], s78 offen offset:1024 lds
    buffer_load_dwordx4 v70, s[44:47], s78 offen offset:2048 lds
    s_mov_b32 s40, s38
    s_and_b32 s41, s39, 0xffff
    s_mov_b32 s42, 12673024
    s_mov_b32 s43, 0x20000
    v_lshrrev_b32 v57, 2, v0
    v_and_b32 v58, 3, v0
    v_mul_u32_u24 v59, 10240, v57
    v_lshlrev_b32 v57, 4, v57
    v_mul_u32_u24 v60, 4640, v58
    v_add_u32 v60, v60, v57
    v_lshl_add_u32 v57, v58, 4, v59
    v_add_u32 v58, 91648, v60
    v_lshlrev_b32 v59, 4, v0
    v_mov_b32 v152, 162752
    v_mov_b32 v153, 0
    ds_write_b32 v152, v153
    buffer_load_dwordx4 v71, s[44:47], s78 offen offset:3072 lds
    s_mov_b32 m0, 7296
    s_nop 0
    buffer_load_dwordx4 v1, s[52:55], s77 offen offset:0 lds
    buffer_load_dwordx4 v2, s[52:55], s77 offen offset:1024 lds
    buffer_load_dwordx4 v3, s[52:55], s77 offen offset:2048 lds
    buffer_load_dwordx4 v4, s[52:55], s77 offen offset:3072 lds
    s_mov_b32 m0, 11392
    s_nop 0
    buffer_load_dwordx4 v5, s[52:55], s77 offen offset:0 lds
    buffer_load_dwordx4 v6, s[52:55], s77 offen offset:1024 lds
    buffer_load_dwordx4 v7, s[52:55], s77 offen offset:2048 lds
    s_add_u32 s77, s77, 110592
    s_cmp_eq_u32 s77, 2211840
    s_cselect_b32 s77, 0, s77
    s_mov_b32 m0, 66560
    s_nop 0
    buffer_load_dwordx4 v72, s[44:47], s78 offen offset:0 lds
    buffer_load_dwordx4 v73, s[44:47], s78 offen offset:1024 lds
    buffer_load_dwordx4 v74, s[44:47], s78 offen offset:2048 lds
    buffer_load_dwordx4 v75, s[44:47], s78 offen offset:3072 lds
    s_mov_b32 m0, 70656
    s_nop 0
    buffer_load_dwordx4 v76, s[44:47], s78 offen offset:0 lds
    buffer_load_dwordx4 v77, s[44:47], s78 offen offset:1024 lds
    buffer_load_dwordx4 v78, s[44:47], s78 offen offset:2048 lds
    buffer_load_dwordx4 v79, s[44:47], s78 offen offset:3072 lds
    s_add_u32 s78, s78, 128
    s_cmp_eq_u32 s78, 1280
    s_cselect_b32 s78, 0, s78
    s_mov_b32 m0, 14592
    s_nop 0
    buffer_load_dwordx4 v1, s[48:51], s77 offen offset:0 lds
    buffer_load_dwordx4 v2, s[48:51], s77 offen offset:1024 lds
    buffer_load_dwordx4 v3, s[48:51], s77 offen offset:2048 lds
    buffer_load_dwordx4 v4, s[48:51], s77 offen offset:3072 lds
    s_mov_b32 m0, 18688
    s_nop 0
    buffer_load_dwordx4 v5, s[48:51], s77 offen offset:0 lds
    buffer_load_dwordx4 v6, s[48:51], s77 offen offset:1024 lds
    buffer_load_dwordx4 v7, s[48:51], s77 offen offset:2048 lds
    s_mov_b32 m0, 21888
    s_nop 0
    buffer_load_dwordx4 v1, s[52:55], s77 offen offset:0 lds
    buffer_load_dwordx4 v2, s[52:55], s77 offen offset:1024 lds
    buffer_load_dwordx4 v3, s[52:55], s77 offen offset:2048 lds
    buffer_load_dwordx4 v4, s[52:55], s77 offen offset:3072 lds
    s_mov_b32 m0, 25984
    s_nop 0
    buffer_load_dwordx4 v5, s[52:55], s77 offen offset:0 lds
    buffer_load_dwordx4 v6, s[52:55], s77 offen offset:1024 lds
    buffer_load_dwordx4 v7, s[52:55], s77 offen offset:2048 lds
    s_add_u32 s77, s77, 110592
    s_cmp_eq_u32 s77, 2211840
    s_cselect_b32 s77, 0, s77
    s_mov_b32 m0, 29184
    s_nop 0
    buffer_load_dwordx4 v1, s[48:51], s77 offen offset:0 lds
    buffer_load_dwordx4 v2, s[48:51], s77 offen offset:1024 lds
    buffer_load_dwordx4 v3, s[48:51], s77 offen offset:2048 lds
    buffer_load_dwordx4 v4, s[48:51], s77 offen offset:3072 lds
    s_mov_b32 m0, 33280
    s_nop 0
    buffer_load_dwordx4 v5, s[48:51], s77 offen offset:0 lds
    buffer_load_dwordx4 v6, s[48:51], s77 offen offset:1024 lds
    s_waitcnt lgkmcnt(0)
    s_mul_i32 s66, s66, 1664525
    s_add_u32 s66, s66, 1013904223
    s_branch L_l_b0
L_ln:
    s_mov_b32 s70, 1065369472
    s_mov_b32 s71, 0xffff0000
    v_mov_b32 v32, 0
    v_mov_b32 v33, 0
    v_dot2c_f32_bf16 v32, s70, v16
    v_dot2c_f32_bf16 v33, s70, v17
    v_dot2c_f32_bf16 v32, s70, v18
    v_dot2c_f32_bf16 v33, s70, v19
    v_dot2c_f32_bf16 v32, s70, v20
    v_lshlrev_b32 v22, 16, v16
    v_and_b32 v23, s71, v16
    v_lshlrev_b32 v24, 16, v17
    v_and_b32 v25, s71, v17
    v_lshlrev_b32 v26, 16, v18
    v_and_b32 v27, s71, v18
    v_lshlrev_b32 v28, 16, v19
    v_and_b32 v29, s71, v19
    v_lshlrev_b32 v30, 16, v20
    v_and_b32 v31, s71, v20
    v_add_f32 v32, v32, v33
    s_nop 1
    v_add_f32_dpp v32, v32, v32 row_ror:8 row_mask:0xf bank_mask:0xf
    s_nop 1
    v_add_f32_dpp v32, v32, v32 row_ror:4 row_mask:0xf bank_mask:0xf
    s_nop 1
    v_add_f32_dpp v32, v32, v32 row_ror:2 row_mask:0xf bank_mask:0xf
    s_nop 1
    v_add_f32_dpp v32, v32, v32 row_ror:1 row_mask:0xf bank_mask:0xf
    v_mov_b32 v33, v32
    s_nop 1
    v_permlane16_swap_b32 v32, v33
    v_add_f32 v32, v32, v33
    v_mov_b32 v33, v32
    s_nop 1
    v_permlane32_swap_b32 v32, v33
    v_add_f32 v32, v32, v33
    v_mul_f32 v32, 0x3acccccd, v32
    v_sub_f32 v36, v22, v32
    v_sub_f32 v37, v23, v32
    v_sub_f32 v38, v24, v32
    v_sub_f32 v39, v25, v32
    v_sub_f32 v40, v26, v32
    v_sub_f32 v41, v27, v32
    v_sub_f32 v42, v28, v32
    v_sub_f32 v43, v29, v32
    v_sub_f32 v44, v30, v32
    v_sub_f32 v45, v31, v32
    v_mul_f32 v33, v36, v36
    v_mul_f32 v34, v37, v37
    v_fmac_f32 v33, v38, v38
    v_fmac_f32 v34, v39, v39
    v_fmac_f32 v33, v40, v40
    v_fmac_f32 v34, v41, v41
    v_fmac_f32 v33, v42, v42
    v_fmac_f32 v34, v43, v43
    v_fmac_f32 v33, v44, v44
    v_fmac_f32 v34, v45, v45
    v_cvt_pk_bf16_f32 v46, v32, v32
    v_add_f32 v33, v33, v34
    v_lshlrev_b32 v32, 16, v46
    s_nop 0
    v_add_f32_dpp v33, v33, v33 row_ror:8 row_mask:0xf bank_mask:0xf
    s_nop 1
    v_add_f32_dpp v33, v33, v33 row_ror:4 row_mask:0xf bank_mask:0xf
    s_nop 1
    v_add_f32_dpp v33, v33, v33 row_ror:2 row_mask:0xf bank_mask:0xf
    s_nop 1
    v_add_f32_dpp v33, v33, v33 row_ror:1 row_mask:0xf bank_mask:0xf
    v_mov_b32 v34, v33
    s_nop 1
    v_permlane16_swap_b32 v33, v34
    v_add_f32 v33, v33, v34
    v_mov_b32 v34, v33
    s_nop 1
    v_permlane32_swap_b32 v33, v34
    v_add_f32 v33, v33, v34
    v_sub_f32 v22, v22, v32
    v_sub_f32 v23, v23, v32
    v_sub_f32 v24, v24, v32
    v_sub_f32 v25, v25, v32
    v_sub_f32 v26, v26, v32
    v_sub_f32 v27, v27, v32
    v_sub_f32 v28, v28, v32
    v_sub_f32 v29, v29, v32
    v_sub_f32 v30, v30, v32
    v_sub_f32 v31, v31, v32
    v_mul_f32 v33, 0x3acccccd, v33
    v_cvt_pk_bf16_f32 v33, v33, v33
    v_lshlrev_b32 v33, 16, v33
    v_add_f32 v33, 0x3727c5ac, v33
    v_cvt_pk_bf16_f32 v33, v33, v33
    v_lshlrev_b32 v33, 16, v33
    v_sqrt_f32 v33, v33
    v_cvt_pk_bf16_f32 v16, v22, v23
    v_cvt_pk_bf16_f32 v17, v24, v25
    v_cvt_pk_bf16_f32 v18, v26, v27
    v_cvt_pk_bf16_f32 v19, v28, v29
    v_cvt_pk_bf16_f32 v20, v30, v31
    v_cvt_pk_bf16_f32 v33, v33, v33
    v_lshlrev_b32 v33, 16, v33
    v_rcp_f32 v33, v33
    v_lshlrev_b32 v22, 16, v16
    v_and_b32 v23, s71, v16
    v_lshlrev_b32 v24, 16, v17
    v_and_b32 v25, s71, v17
    v_lshlrev_b32 v26, 16, v18
    v_and_b32 v27, s71, v18
    v_lshlrev_b32 v28, 16, v19
    v_and_b32 v29, s71, v19
    v_lshlrev_b32 v30, 16, v20
    v_and_b32 v31, s71, v20
    v_mul_f32 v22, v33, v22
    v_mul_f32 v23, v33, v23
    v_mul_f32 v24, v33, v24
    v_mul_f32 v25, v33, v25
    v_mul_f32 v26, v33, v26
    v_mul_f32 v27, v33, v27
    v_mul_f32 v28, v33, v28
    v_mul_f32 v29, v33, v29
    v_mul_f32 v30, v33, v30
    v_mul_f32 v31, v33, v31
    s_mul_i32 s70, s1, 1344
    s_add_u32 s70, s70, 121696
    v_add_u32 v55, s70, v55
    v_cvt_pk_bf16_f32 v16, v22, v23
    ds_write_b32 v55, v16 offset:0
    v_cvt_pk_bf16_f32 v17, v24, v25
    ds_write_b32 v55, v17 offset:4
    v_cvt_pk_bf16_f32 v18, v26, v27
    ds_write_b32 v55, v18 offset:8
    v_cvt_pk_bf16_f32 v19, v28, v29
    ds_write_b32 v55, v19 offset:12
    v_cvt_pk_bf16_f32 v20, v30, v31
    ds_write_b32 v55, v20 offset:16
    v_xor_b32 v46, 0x80008000, v46
    v_mul_f32 v47, v33, v33
    s_lshl_b32 s70, s1, 3
    s_add_u32 s70, s70, 132448
    v_mov_b32 v55, s70
    ds_write_b64 v55, v[46:47]
    s_cmp_eq_u32 s98, 3
    s_cbranch_scc1 L_ln2
    s_mul_i32 s66, s66, 1664525
    s_add_u32 s66, s66, 1013904223
    s_cmp_eq_u32 s98, 2
    s_cbranch_scc1 L_w_b0
    s_branch L_g_b0
L_ln2:
    v_mov_b32 v16, v224
    v_mov_b32 v17, v225
    v_mov_b32 v18, v226
    v_mov_b32 v19, v227
    v_mov_b32 v20, v228
    v_mul_u32_u24 v55, 20, v0
    s_mov_b32 s1, 4
    s_mov_b32 s98, 0
    s_branch L_ln
L_matrix:
    s_mov_b32 s98, 0
    s_and_b32 s3, s57, 1
    s_lshr_b32 s4, s57, 1
    v_and_b32 v56, 15, v0
    v_lshrrev_b32 v56, 2, v56
    v_lshrrev_b32 v57, 5, v0
    v_lshl_add_u32 v56, v57, 3, v56
    v_mul_u32_u24 v56, 224, v56
    v_bfe_u32 v58, v0, 4, 1
    v_mul_u32_u24 v58, 7296, v58
    v_and_b32 v59, 3, v0
    v_lshlrev_b32 v59, 3, v59
    v_add3_u32 v56, v56, v58, v59
    s_mul_i32 s69, s3, 3584
    s_sub_u32 s70, 3584, s69
    s_mul_i32 s71, s4, 96
    s_add_u32 s72, s69, s71
    v_add_u32 v1, s72, v56
    s_add_u32 s72, s70, s71
    v_add_u32 v2, s72, v56
    s_add_u32 s72, s69, 192
    v_add_u32 v3, s72, v56
    s_add_u32 s72, s70, 192
    v_add_u32 v4, s72, v56
    v_and_b32 v58, 31, v0
    v_lshlrev_b32 v59, 7, v58
    v_bfe_u32 v60, v0, 1, 3
    s_lshl_b32 s69, s3, 1
    v_add_u32 v61, s69, v57
    v_xor_b32 v62, v61, v60
    v_lshl_add_u32 v62, v62, 4, v59
    s_lshl_b32 s69, s3, 13
    s_add_u32 s69, s69, 58368
    s_lshl_b32 s70, s4, 12
    s_add_u32 s71, s69, s70
    s_sub_u32 s72, s69, s70
    s_add_u32 s72, s72, 4096
    v_add_u32 v5, s71, v62
    v_add_u32 v6, s72, v62
    v_xor_b32 v63, 32, v62
    v_add_u32 v7, s71, v63
    v_add_u32 v8, s72, v63
    v_xor_b32 v63, 64, v62
    v_add_u32 v10, s71, v63
    v_add_u32 v11, s72, v63
    v_xor_b32 v63, 96, v62
    v_add_u32 v12, s71, v63
    v_add_u32 v13, s72, v63
    s_waitcnt lgkmcnt(0)
    s_load_dword s66, s[38:39], 0
    s_mov_b32 s1, s56
    s_mov_b32 s44, s8
    s_and_b32 s45, s9, 0xffff
    s_mov_b32 s46, 2621440
    s_mov_b32 s47, 0x20000
    buffer_load_dwordx4 v[16:19], v54, s[44:47], 0 offen
    buffer_load_dword v20, v54, s[44:47], 0 offen offset:16
    s_cmp_eq_u32 s57, 0
    s_cselect_b32 s98, 3, 0
    s_cselect_b32 s69, 5120, 1073741824
    buffer_load_dwordx4 v[224:227], v54, s[44:47], s69 offen
    buffer_load_dword v228, v54, s[44:47], s69 offen offset:16
    s_getpc_b64 s[100:101]
L_pc:
    s_lshr_b32 s69, s2, 3
    s_lshl_b32 s69, s69, 2
    s_add_u32 s69, s69, s57
    s_lshl_b32 s69, s69, 8
    v_lshl_add_u32 v230, v0, 2, s69
    v_min_u32 v230, L_exit-L_pc, v230
    v_mov_b32 v231, s101
    v_add_co_u32 v230, vcc, s100, v230
    s_nop 1
    v_addc_co_u32 v231, vcc, 0, v231, vcc
    global_load_dword v255, v[230:231], off
    s_mov_b32 s40, s38
    s_and_b32 s41, s39, 0xffff
    s_mov_b32 s42, 12673024
    s_mov_b32 s43, 0x20000
    s_mov_b32 s48, s32
    s_and_b32 s49, s33, 0xffff
    s_mov_b32 s50, 2211840
    s_mov_b32 s51, 0x20000
    s_mov_b32 s52, s34
    s_and_b32 s53, s35, 0xffff
    s_mov_b32 s54, 2621440
    s_mov_b32 s55, 0x20000
    v_bfe_u32 v60, v0, 4, 1
    v_mul_u32_u24 v60, 57344, v60
    v_and_b32 v61, 15, v0
    v_lshl_add_u32 v61, v57, 4, v61
    v_lshl_add_u32 v9, v61, 4, v60
    v_mov_b32 v56, 0
    v_mov_b32 v57, 0
    v_mov_b32 v58, 0
    v_mov_b32 v59, 0
    s_nop 1
    v_mfma_f32_32x32x16_bf16 v[64:79], v[56:59], v[56:59], 0
    v_mfma_f32_32x32x16_bf16 v[80:95], v[56:59], v[56:59], 0
    v_mfma_f32_32x32x16_bf16 v[96:111], v[56:59], v[56:59], 0
    v_mfma_f32_32x32x16_bf16 v[112:127], v[56:59], v[56:59], 0
    v_mfma_f32_32x32x16_bf16 v[128:143], v[56:59], v[56:59], 0
    v_mfma_f32_32x32x16_bf16 v[144:159], v[56:59], v[56:59], 0
    v_mfma_f32_32x32x16_bf16 v[160:175], v[56:59], v[56:59], 0
    v_mfma_f32_32x32x16_bf16 v[192:207], v[56:59], v[56:59], 0
    v_mfma_f32_32x32x16_bf16 v[208:223], v[56:59], v[56:59], 0
    s_waitcnt vmcnt(1) lgkmcnt(0)
    s_branch L_ln
L_worker:
    s_mov_b32 s98, 2
    s_sub_u32 s3, s56, 5
    s_add_u32 s7, s65, s3
    s_min_u32 s7, s7, 639
    s_setprio 1
    s_lshl_b32 s69, s7, 8
    v_lshl_add_u32 v1, v0, 2, s69
    s_lshl_b32 s69, s7, 1
    v_mov_b32 v13, s69
    v_and_b32 v56, 15, v0
    v_lshrrev_b32 v57, 4, v0
    v_lshlrev_b32 v58, 3, v56
    v_cvt_f32_u32 v2, v58
    v_lshrrev_b32 v59, 3, v56
    v_and_b32 v60, 7, v56
    v_lshl_add_u32 v58, v59, 7, v60
    v_cvt_f32_u32 v3, v58
    v_lshlrev_b32 v58, 7, v60
    v_add_u32 v58, 1024, v58
    v_cvt_f32_u32 v5, v58
    v_lshrrev_b32 v58, 2, v60
    v_lshlrev_b32 v58, 7, v58
    v_and_b32 v61, 3, v60
    v_lshl_add_u32 v58, v61, 1, v58
    v_add_u32 v58, 256, v58
    v_lshrrev_b32 v61, 1, v60
    v_lshlrev_b32 v61, 7, v61
    v_and_b32 v62, 1, v60
    v_lshl_add_u32 v61, v62, 2, v61
    v_add_u32 v61, 512, v61
    v_cmp_lt_u32 vcc, 7, v56
    s_nop 1
    v_cndmask_b32 v58, v58, v61, vcc
    v_cvt_f32_u32 v4, v58
    s_mul_i32 s75, s3, 2592
    s_add_u32 s75, s75, 154976
    v_lshl_add_u32 v6, v57, 6, s75
    v_lshl_add_u32 v7, v59, 8, v6
    v_lshl_add_u32 v8, v0, 5, s75
    v_lshlrev_b32 v11, 4, v0
    v_lshrrev_b32 v58, 1, v57
    v_and_b32 v59, 1, v57
    v_lshlrev_b32 v60, 9, v58
    v_lshl_add_u32 v60, v59, 4, v60
    v_lshl_add_u32 v60, v56, 5, v60
    v_add_u32 v64, s75, v60
    v_lshlrev_b32 v60, 8, v59
    v_add_u32 v60, s75, v60
    v_lshl_add_u32 v61, v56, 4, v60
    v_add_u32 v61, 1024, v61
    v_lshl_add_u32 v62, v56, 3, v60
    v_add_u32 v62, 1536, v62
    v_cmp_lt_u32 vcc, 31, v0
    s_nop 1
    v_cndmask_b32 v65, v61, v62, vcc
    v_add_u32 v61, 8, v61
    v_add_u32 v62, 128, v62
    v_cndmask_b32 v66, v61, v62, vcc
    v_lshl_add_u32 v60, v56, 2, v60
    v_add_u32 v67, 2048, v60
    s_waitcnt lgkmcnt(0)
    s_load_dword s66, s[38:39], 0
    s_mov_b32 s1, s56
    s_mov_b32 s44, s8
    s_and_b32 s45, s9, 0xffff
    s_mov_b32 s46, 2621440
    s_mov_b32 s47, 0x20000
    buffer_load_dwordx4 v[16:19], v54, s[44:47], 0 offen
    buffer_load_dword v20, v54, s[44:47], 0 offen offset:16
    s_mov_b32 s40, s38
    s_and_b32 s41, s39, 0xffff
    s_mov_b32 s42, 12673024
    s_mov_b32 s43, 0x20000
    s_add_u32 s69, s75, 2296
    v_lshlrev_b32 v58, 2, v0
    v_sub_u32 v68, s69, v58
    s_add_u32 s69, s75, 2032
    v_lshlrev_b32 v58, 3, v0
    v_sub_u32 v69, s69, v58
    v_sub_u32 v58, 63, v0
    v_lshlrev_b32 v59, 4, v58
    v_add_u32 v59, 496, v59
    v_lshlrev_b32 v58, 5, v58
    v_subrev_u32 v58, 16, v58
    v_cndmask_b32 v58, v59, v58, vcc
    v_add_u32 v70, s75, v58
    s_mul_i32 s70, s3, 16640
    s_add_u32 s70, s70, 105056
    v_add_u32 v71, s70, v11
    v_bfe_u32 v58, v0, 2, 2
    v_mul_u32_u24 v59, 4160, v58
    v_and_b32 v60, 3, v0
    v_lshl_add_u32 v59, v60, 4, v59
    s_add_u32 s70, s70, 4096
    v_add_u32 v59, s70, v59
    s_mul_i32 s70, s3, 4640
    s_add_u32 s70, s70, 90624
    v_add_u32 v61, s70, v11
    v_cndmask_b32 v12, v59, v61, vcc
    v_mul_u32_u24 v58, 1344, v58
    v_lshl_add_u32 v58, v57, 5, v58
    v_lshl_add_u32 v58, v60, 3, v58
    v_add_u32 v10, 122848, v58
    s_lshl_b32 s70, s3, 7
    s_add_u32 s70, s70, 121696
    v_add_u32 v9, s70, v58
    global_load_ushort v62, v13, s[22:23]
    global_load_dword v56, v1, s[10:11]
    global_load_dword v57, v1, s[12:13]
    global_load_dword v58, v1, s[14:15]
    global_load_dword v59, v1, s[16:17]
    global_load_dword v60, v1, s[18:19]
    global_load_dword v61, v1, s[20:21]
    global_load_ushort v63, v13, s[24:25]
    v_mov_b32 v148, 0
    v_mov_b32 v149, 0
    v_mov_b32 v150, 0
    v_mov_b32 v151, 0
    s_nop 1
    v_mfma_f32_32x32x16_bf16 v[132:147], v[148:151], v[148:151], 0
    s_waitcnt vmcnt(8) lgkmcnt(0)
    s_branch L_ln
L_w_b0:
    s_waitcnt lgkmcnt(0)
    s_barrier
    ds_read_b64_tr_b16 v[36:37], v9 offset:0
    ds_read_b64_tr_b16 v[38:39], v9 offset:5376
    ds_read_b64_tr_b16 v[40:41], v9 offset:384
    ds_read_b64_tr_b16 v[42:43], v9 offset:5760
    ds_read_b64_tr_b16 v[44:45], v9 offset:768
    ds_read_b64_tr_b16 v[46:47], v9 offset:6144
    ds_read_b64_tr_b16 v[48:49], v10 offset:0
    ds_read_b64_tr_b16 v[50:51], v10 offset:5376
    v_and_b32 v14, 7, v0
    v_lshlrev_b32 v14, 3, v14
    v_add_u32 v15, 132448, v14
    ds_read_b64 v[52:53], v15
    s_mul_i32 s69, s2, 10240
    s_add_u32 s69, s69, 90112
    s_add_u32 s72, s69, 9216
    s_lshl_b32 s70, s3, 10
    s_add_u32 s70, s70, s69
    s_add_u32 s71, s70, 6144
    s_lshl_b32 s73, s2, 6
    s_add_u32 s73, s73, 16384
    s_waitcnt lgkmcnt(0)
    buffer_store_dwordx4 v[36:39], v11, s[40:43], s70 offen offset:0 sc1
    buffer_store_dwordx4 v[40:43], v11, s[40:43], s70 offen offset:3072 sc1
    buffer_store_dwordx4 v[44:47], v11, s[40:43], s71 offen offset:0 sc1
    buffer_store_dwordx4 v[48:51], v11, s[40:43], s72 offen offset:0 sc1
    s_mov_b64 exec, 0xff
    buffer_store_dwordx2 v[52:53], v14, s[40:43], s73 offen sc1
    s_mov_b64 exec, -1
    s_mov_b32 s4, 20
    s_cmp_ge_u32 s3, s64
    s_cbranch_scc1 L_idle
    s_waitcnt vmcnt(5)
    v_lshlrev_b32 v62, 16, v62
    v_mul_f32 v62, 1069066811, v62
    v_exp_f32 v62, v62
    v_lshlrev_b32 v63, 16, v63
    v_cvt_pk_bf16_f32 v62, v62, v62
    v_lshlrev_b32 v62, 16, v62
    v_lshlrev_b32 v24, 16, v56
    v_lshlrev_b32 v25, 16, v57
    v_lshlrev_b32 v26, 16, v58
    v_lshlrev_b32 v27, 16, v59
    v_lshlrev_b32 v28, 16, v60
    v_lshlrev_b32 v29, 16, v61
    v_mul_f32 v16, v62, v24
    v_mul_f32 v17, v62, v25
    v_mul_f32 v26, v62, v26
    v_mul_f32 v17, 1042479491, v17
    v_mul_f32 v27, v62, v27
    v_mul_f32 v16, 1069066811, v16
    v_rndne_f32 v30, v17
    v_mul_f32 v18, v28, v26
    v_sub_f32 v17, v17, v30
    v_mul_f32 v19, v28, v27
    v_mul_f32 v30, 0x45000000, v16
    v_mul_f32 v31, 0x45000000, v17
    v_fma_f32 v18, -v29, v27, v18
    v_fract_f32 v31, v31
    v_fma_f32 v19, -v29, v26, -v19
    v_exp_f32 v30, v30
    v_sin_f32 v32, v31
    v_cos_f32 v31, v31
    ds_write_b128 v8, v[16:19] offset:0
    v_mul_f32 v31, v18, v31
    v_fmac_f32 v31, v19, v32
    v_mul_f32 v34, v30, v31
    s_cmp_eq_u32 s4, 0
    s_cbranch_scc1 L_nobar_1
    s_sub_u32 s4, s4, 1
    s_barrier
L_nobar_1:
    v_and_b32 v24, 0xffff0000, v56
    v_and_b32 v25, 0xffff0000, v57
    v_and_b32 v26, 0xffff0000, v58
    v_and_b32 v27, 0xffff0000, v59
    v_and_b32 v28, 0xffff0000, v60
    v_and_b32 v29, 0xffff0000, v61
    v_mul_f32 v20, v62, v24
    v_mul_f32 v21, v62, v25
    v_mul_f32 v26, v62, v26
    v_mul_f32 v21, 1042479491, v21
    v_mul_f32 v27, v62, v27
    v_mul_f32 v20, 1069066811, v20
    v_rndne_f32 v30, v21
    v_mul_f32 v22, v28, v26
    v_sub_f32 v21, v21, v30
    v_mul_f32 v23, v28, v27
    v_mul_f32 v30, 0x45000000, v20
    v_mul_f32 v31, 0x45000000, v21
    v_fma_f32 v22, -v29, v27, v22
    v_fract_f32 v31, v31
    v_fma_f32 v23, -v29, v26, -v23
    v_exp_f32 v30, v30
    v_sin_f32 v32, v31
    v_cos_f32 v31, v31
    ds_write_b128 v8, v[20:23] offset:16
    v_mul_f32 v31, v22, v31
    v_fmac_f32 v31, v23, v32
    v_mul_f32 v35, v30, v31
    ds_read_b128 v[72:75], v6 offset:0
    ds_read_b128 v[76:79], v6 offset:16
    ds_read_b128 v[80:83], v6 offset:32
    ds_read_b128 v[84:87], v6 offset:48
    ds_read_b64 v[104:105], v7 offset:0
    ds_read_b64 v[106:107], v7 offset:16
    ds_read_b64 v[108:109], v7 offset:32
    ds_read_b64 v[110:111], v7 offset:48
    ds_read_b128 v[88:91], v6 offset:256
    ds_read_b128 v[92:95], v6 offset:272
    ds_read_b128 v[96:99], v6 offset:288
    ds_read_b128 v[100:103], v6 offset:304
    v_mov_b32 v16, 0
    v_mov_b32 v17, 0
    v_mov_b32 v18, 0
    v_mov_b32 v19, 0
    v_add_f32 v34, v34, v35
    v_readfirstlane_b32 s6, v63
    s_nop 0
    v_add_f32_dpp v34, v34, v34 row_ror:8 row_mask:0xf bank_mask:0xf
    s_nop 1
    v_add_f32_dpp v34, v34, v34 row_ror:4 row_mask:0xf bank_mask:0xf
    s_nop 1
    v_add_f32_dpp v34, v34, v34 row_ror:2 row_mask:0xf bank_mask:0xf
    s_nop 1
    v_add_f32_dpp v34, v34, v34 row_ror:1 row_mask:0xf bank_mask:0xf
    v_mov_b32 v35, v34
    s_nop 1
    v_permlane16_swap_b32 v34, v35
    v_add_f32 v34, v34, v35
    v_mov_b32 v35, v34
    s_nop 1
    v_permlane32_swap_b32 v34, v35
    v_add_f32 v34, v34, v35
    ds_write_b128 v12, v[16:19]
    v_readfirstlane_b32 s5, v34
    s_waitcnt lgkmcnt(0)
    s_cmp_eq_u32 s4, 0
    s_cbranch_scc1 L_nobar_2
    s_sub_u32 s4, s4, 1
    s_barrier
L_nobar_2:
    s_mov_b32 s74, 4
.p2align 6
L_kg:
    s_waitcnt lgkmcnt(4)
    v_mul_f32 v148, v2, v72
    v_mul_f32 v149, v2, v73
    v_mul_f32 v152, v2, v76
    v_mul_f32 v153, v2, v77
    v_mul_f32 v156, v2, v80
    v_mul_f32 v157, v2, v81
    v_mul_f32 v160, v2, v84
    v_mul_f32 v161, v2, v85
    v_exp_f32 v148, v148
    v_sin_f32 v150, v149
    v_cos_f32 v149, v149
    v_exp_f32 v152, v152
    v_sin_f32 v154, v153
    v_cos_f32 v153, v153
    v_exp_f32 v156, v156
    v_sin_f32 v158, v157
    v_cos_f32 v157, v157
    v_exp_f32 v160, v160
    v_sin_f32 v162, v161
    v_cos_f32 v161, v161
    v_mul_f32 v150, v148, v150
    v_mul_f32 v149, v148, v149
    v_mul_f32 v154, v152, v154
    v_mul_f32 v153, v152, v153
    v_mul_f32 v158, v156, v158
    v_mul_f32 v157, v156, v157
    v_mul_f32 v162, v160, v162
    v_mul_f32 v161, v160, v161
    v_mul_f32 v148, v74, v149
    v_mul_f32 v151, v75, v149
    v_mul_f32 v152, v78, v153
    v_mul_f32 v155, v79, v153
    v_mul_f32 v156, v82, v157
    v_mul_f32 v159, v83, v157
    v_mul_f32 v160, v86, v161
    v_mul_f32 v163, v87, v161
    v_fmac_f32 v148, v75, v150
    v_fma_f32 v151, -v74, v150, v151
    v_fmac_f32 v152, v79, v154
    v_fma_f32 v155, -v78, v154, v155
    v_fmac_f32 v156, v83, v158
    v_fma_f32 v159, -v82, v158, v159
    v_fmac_f32 v160, v87, v162
    v_fma_f32 v163, -v86, v162, v163
    v_cvt_pk_bf16_f32 v112, v148, v151
    v_cvt_pk_bf16_f32 v113, v152, v155
    v_cvt_pk_bf16_f32 v114, v156, v159
    v_cvt_pk_bf16_f32 v115, v160, v163
    v_mul_f32 v148, v3, v72
    v_mul_f32 v149, v3, v73
    s_cmp_eq_u32 s4, 0
    s_cbranch_scc1 L_nobar_3
    s_sub_u32 s4, s4, 1
    s_barrier
L_nobar_3:
    v_mul_f32 v152, v3, v76
    v_mul_f32 v153, v3, v77
    v_mul_f32 v156, v3, v80
    v_mul_f32 v157, v3, v81
    v_mul_f32 v160, v3, v84
    v_mul_f32 v161, v3, v85
    v_exp_f32 v148, v148
    v_sin_f32 v150, v149
    v_cos_f32 v149, v149
    v_exp_f32 v152, v152
    v_sin_f32 v154, v153
    v_cos_f32 v153, v153
    v_exp_f32 v156, v156
    v_sin_f32 v158, v157
    v_cos_f32 v157, v157
    v_exp_f32 v160, v160
    v_sin_f32 v162, v161
    v_cos_f32 v161, v161
    v_mul_f32 v150, v148, v150
    v_mul_f32 v149, v148, v149
    v_mul_f32 v154, v152, v154
    v_mul_f32 v153, v152, v153
    v_mul_f32 v158, v156, v158
    v_mul_f32 v157, v156, v157
    v_mul_f32 v162, v160, v162
    v_mul_f32 v161, v160, v161
    v_cvt_pk_bf16_f32 v120, v149, v150
    v_cvt_pk_bf16_f32 v121, v153, v154
    v_cvt_pk_bf16_f32 v122, v157, v158
    v_cvt_pk_bf16_f32 v123, v161, v162
    v_mul_f32 v148, v4, v72
    v_mul_f32 v149, v4, v73
    v_mul_f32 v152, v4, v76
    v_mul_f32 v153, v4, v77
    v_mul_f32 v156, v4, v80
    v_mul_f32 v157, v4, v81
    v_mul_f32 v160, v4, v84
    v_mul_f32 v161, v4, v85
    v_fract_f32 v149, v149
    v_fract_f32 v153, v153
    v_mfma_f32_16x16x32_bf16 v[132:135], v[120:123], v[112:115], v[132:135]
    v_fract_f32 v157, v157
    v_fract_f32 v161, v161
    v_exp_f32 v148, v148
    v_sin_f32 v150, v149
    v_cos_f32 v149, v149
    v_exp_f32 v152, v152
    s_cmp_eq_u32 s4, 0
    s_cbranch_scc1 L_nobar_4
    s_sub_u32 s4, s4, 1
    s_barrier
L_nobar_4:
    v_sin_f32 v154, v153
    v_cos_f32 v153, v153
    v_exp_f32 v156, v156
    v_sin_f32 v158, v157
    v_cos_f32 v157, v157
    v_exp_f32 v160, v160
    v_sin_f32 v162, v161
    v_cos_f32 v161, v161
    v_mul_f32 v150, v148, v150
    v_mul_f32 v149, v148, v149
    v_mul_f32 v154, v152, v154
    v_mul_f32 v153, v152, v153
    v_mul_f32 v158, v156, v158
    v_mul_f32 v157, v156, v157
    v_mul_f32 v162, v160, v162
    v_mul_f32 v161, v160, v161
    v_cvt_pk_bf16_f32 v124, v149, v150
    v_cvt_pk_bf16_f32 v125, v153, v154
    v_cvt_pk_bf16_f32 v126, v157, v158
    v_cvt_pk_bf16_f32 v127, v161, v162
    v_add_u32 v6, 512, v6
    v_add_u32 v7, 512, v7
    s_waitcnt lgkmcnt(0)
    v_mul_f32 v148, v5, v104
    v_mul_f32 v149, v5, v105
    v_mul_f32 v152, v5, v106
    v_mul_f32 v153, v5, v107
    v_mul_f32 v156, v5, v108
    v_mul_f32 v157, v5, v109
    v_mul_f32 v160, v5, v110
    v_mul_f32 v161, v5, v111
    v_fract_f32 v149, v149
    v_fract_f32 v153, v153
    v_mfma_f32_16x16x32_bf16 v[136:139], v[124:127], v[112:115], v[136:139]
    ds_read_b128 v[72:75], v6 offset:0
    ds_read_b128 v[76:79], v6 offset:16
    ds_read_b128 v[80:83], v6 offset:32
    ds_read_b128 v[84:87], v6 offset:48
    v_fract_f32 v157, v157
    v_fract_f32 v161, v161
    v_exp_f32 v148, v148
    v_sin_f32 v150, v149
    v_cos_f32 v149, v149
    v_exp_f32 v152, v152
    v_sin_f32 v154, v153
    v_cos_f32 v153, v153
    v_exp_f32 v156, v156
    s_cmp_eq_u32 s4, 0
    s_cbranch_scc1 L_nobar_5
    s_sub_u32 s4, s4, 1
    s_barrier
L_nobar_5:
    v_sin_f32 v158, v157
    v_cos_f32 v157, v157
    v_exp_f32 v160, v160
    v_sin_f32 v162, v161
    v_cos_f32 v161, v161
    v_mul_f32 v150, v148, v150
    v_mul_f32 v149, v148, v149
    v_mul_f32 v154, v152, v154
    v_mul_f32 v153, v152, v153
    v_mul_f32 v158, v156, v158
    v_mul_f32 v157, v156, v157
    v_mul_f32 v162, v160, v162
    v_mul_f32 v161, v160, v161
    v_cvt_pk_bf16_f32 v128, v149, v150
    v_cvt_pk_bf16_f32 v129, v153, v154
    v_cvt_pk_bf16_f32 v130, v157, v158
    v_cvt_pk_bf16_f32 v131, v161, v162
    v_mul_f32 v148, v2, v88
    v_mul_f32 v149, v2, v89
    v_mul_f32 v152, v2, v92
    v_mul_f32 v153, v2, v93
    v_mul_f32 v156, v2, v96
    v_mul_f32 v157, v2, v97
    v_mfma_f32_16x16x32_bf16 v[140:143], v[128:131], v[112:115], v[140:143]
    ds_read_b64 v[104:105], v7 offset:0
    ds_read_b64 v[106:107], v7 offset:16
    ds_read_b64 v[108:109], v7 offset:32
    ds_read_b64 v[110:111], v7 offset:48
    v_mul_f32 v160, v2, v100
    v_mul_f32 v161, v2, v101
    v_exp_f32 v148, v148
    v_sin_f32 v150, v149
    v_cos_f32 v149, v149
    v_exp_f32 v152, v152
    v_sin_f32 v154, v153
    v_cos_f32 v153, v153
    v_exp_f32 v156, v156
    v_sin_f32 v158, v157
    v_cos_f32 v157, v157
    v_exp_f32 v160, v160
    v_sin_f32 v162, v161
    v_cos_f32 v161, v161
    v_mul_f32 v150, v148, v150
    v_mul_f32 v149, v148, v149
    v_mul_f32 v154, v152, v154
    s_waitcnt vmcnt(0)
    s_cmp_eq_u32 s4, 0
    s_cbranch_scc1 L_nobar_6
    s_sub_u32 s4, s4, 1
    s_barrier
L_nobar_6:
    v_mul_f32 v153, v152, v153
    v_mul_f32 v158, v156, v158
    v_mul_f32 v157, v156, v157
    v_mul_f32 v162, v160, v162
    v_mul_f32 v161, v160, v161
    v_mul_f32 v148, v90, v149
    v_mul_f32 v151, v91, v149
    v_mul_f32 v152, v94, v153
    v_mul_f32 v155, v95, v153
    v_mul_f32 v156, v98, v157
    v_mul_f32 v159, v99, v157
    v_mul_f32 v160, v102, v161
    v_mul_f32 v163, v103, v161
    v_fmac_f32 v148, v91, v150
    v_fma_f32 v151, -v90, v150, v151
    v_fmac_f32 v152, v95, v154
    v_fma_f32 v155, -v94, v154, v155
    v_fmac_f32 v156, v99, v158
    v_fma_f32 v159, -v98, v158, v159
    v_fmac_f32 v160, v103, v162
    v_fma_f32 v163, -v102, v162, v163
    v_cvt_pk_bf16_f32 v116, v148, v151
    v_cvt_pk_bf16_f32 v117, v152, v155
    v_cvt_pk_bf16_f32 v118, v156, v159
    v_cvt_pk_bf16_f32 v119, v160, v163
    v_mul_f32 v148, v3, v88
    v_mul_f32 v149, v3, v89
    v_mul_f32 v152, v3, v92
    v_mul_f32 v153, v3, v93
    v_mul_f32 v156, v3, v96
    v_mul_f32 v157, v3, v97
    v_mfma_f32_16x16x32_bf16 v[144:147], v[128:131], v[116:119], v[144:147]
    v_mul_f32 v160, v3, v100
    v_mul_f32 v161, v3, v101
    v_exp_f32 v148, v148
    v_sin_f32 v150, v149
    v_cos_f32 v149, v149
    v_exp_f32 v152, v152
    v_sin_f32 v154, v153
    v_cos_f32 v153, v153
    v_exp_f32 v156, v156
    v_sin_f32 v158, v157
    v_cos_f32 v157, v157
    v_exp_f32 v160, v160
    v_sin_f32 v162, v161
    v_cos_f32 v161, v161
    v_mul_f32 v150, v148, v150
    v_mul_f32 v149, v148, v149
    v_mul_f32 v154, v152, v154
    v_mul_f32 v153, v152, v153
    s_cmp_eq_u32 s4, 0
    s_cbranch_scc1 L_nobar_7
    s_sub_u32 s4, s4, 1
    s_barrier
L_nobar_7:
    v_mul_f32 v158, v156, v158
    v_mul_f32 v157, v156, v157
    v_mul_f32 v162, v160, v162
    v_mul_f32 v161, v160, v161
    v_cvt_pk_bf16_f32 v120, v149, v150
    v_cvt_pk_bf16_f32 v121, v153, v154
    v_cvt_pk_bf16_f32 v122, v157, v158
    v_cvt_pk_bf16_f32 v123, v161, v162
    v_mul_f32 v148, v4, v88
    v_mul_f32 v149, v4, v89
    v_mul_f32 v152, v4, v92
    v_mul_f32 v153, v4, v93
    v_mul_f32 v156, v4, v96
    v_mul_f32 v157, v4, v97
    v_mul_f32 v160, v4, v100
    v_mul_f32 v161, v4, v101
    v_fract_f32 v149, v149
    v_fract_f32 v153, v153
    v_mfma_f32_16x16x32_bf16 v[132:135], v[120:123], v[116:119], v[132:135]
    v_fract_f32 v157, v157
    v_fract_f32 v161, v161
    v_exp_f32 v148, v148
    v_sin_f32 v150, v149
    v_cos_f32 v149, v149
    v_exp_f32 v152, v152
    v_sin_f32 v154, v153
    v_cos_f32 v153, v153
    v_exp_f32 v156, v156
    v_sin_f32 v158, v157
    v_cos_f32 v157, v157
    v_exp_f32 v160, v160
    v_sin_f32 v162, v161
    v_cos_f32 v161, v161
    v_mul_f32 v150, v148, v150
    v_mul_f32 v149, v148, v149
    v_mul_f32 v154, v152, v154
    v_mul_f32 v153, v152, v153
    v_mul_f32 v158, v156, v158
    v_mul_f32 v157, v156, v157
    v_mul_f32 v162, v160, v162
    v_mul_f32 v161, v160, v161
    v_cvt_pk_bf16_f32 v124, v149, v150
    v_cvt_pk_bf16_f32 v125, v153, v154
    v_cvt_pk_bf16_f32 v126, v157, v158
    v_cvt_pk_bf16_f32 v127, v161, v162
    ds_read_b128 v[88:91], v6 offset:256
    ds_read_b128 v[92:95], v6 offset:272
    ds_read_b128 v[96:99], v6 offset:288
    ds_read_b128 v[100:103], v6 offset:304
    v_mfma_f32_16x16x32_bf16 v[136:139], v[124:127], v[116:119], v[136:139]
    s_cmp_eq_u32 s4, 0
    s_cbranch_scc1 L_nobar_8
    s_sub_u32 s4, s4, 1
    s_barrier
L_nobar_8:
    s_sub_u32 s74, s74, 1
    s_cmp_lg_u32 s74, 0
    s_cbranch_scc1 L_kg
    v_mov_b32 v16, s6
    v_cmp_eq_u32 vcc, 0, v0
    s_nop 1
    v_cndmask_b32 v16, 0, v16, vcc
    v_mov_b32 v17, s5
    v_mov_b32 v18, s75
    s_waitcnt lgkmcnt(0)
    ds_write_b32 v18, v17 offset:2560
    v_permlane32_swap_b32 v144, v20
    v_permlane32_swap_b32 v145, v21
    v_permlane32_swap_b32 v146, v22
    v_permlane32_swap_b32 v147, v23
    v_add_f32 v132, v132, v16
    v_add_f32 v140, v140, v20
    v_add_f32 v141, v141, v21
    v_add_f32 v142, v142, v22
    v_add_f32 v143, v143, v23
    ds_write_b128 v64, v[132:135]
    ds_write_b64 v65, v[136:137]
    ds_write_b64 v66, v[138:139]
    s_mov_b32 exec_hi, 0
    ds_write_b32 v67, v140 offset:0
    ds_write_b32 v67, v141 offset:64
    ds_write_b32 v67, v142 offset:128
    ds_write_b32 v67, v143 offset:192
    s_mov_b32 exec_hi, -1
    ds_read2_b32 v[24:25], v68 offset0:65 offset1:66
    ds_read2_b32 v[26:27], v68 offset0:1 offset1:2
    ds_read_b32 v33, v68
    ds_read2_b64 v[28:31], v69 offset0:0 offset1:1
    ds_read_b32 v32, v69 offset:16
    ds_read_b128 v[72:75], v70
    ds_read_b128 v[76:79], v70 offset:16
    ds_read_b128 v[80:83], v70 offset:32
    s_mov_b32 vcc_lo, 0xaaaaaaaa
    s_mov_b32 vcc_hi, 0xaaaaaaaa
    s_waitcnt lgkmcnt(6)
    v_cndmask_b32 v34, v25, v24, vcc
    v_cndmask_b32 v35, v27, v26, vcc
    v_cvt_pk_bf16_f32 v88, v34, v24
    v_cvt_pk_bf16_f32 v89, v24, v24
    v_cvt_pk_bf16_f32 v90, v24, v24
    v_cvt_pk_bf16_f32 v91, v24, v24
    ds_write_b128 v71, v[88:91] offset:0
    v_cvt_pk_bf16_f32 v92, v25, v34
    v_cvt_pk_bf16_f32 v93, v24, v24
    v_cvt_pk_bf16_f32 v94, v24, v24
    v_cvt_pk_bf16_f32 v95, v24, v24
    ds_write_b128 v71, v[92:95] offset:4160
    v_cvt_pk_bf16_f32 v96, v25, v25
    v_cvt_pk_bf16_f32 v97, v34, v24
    v_cvt_pk_bf16_f32 v98, v24, v24
    v_cvt_pk_bf16_f32 v99, v24, v24
    ds_write_b128 v71, v[96:99] offset:8320
    v_cvt_pk_bf16_f32 v100, v25, v25
    v_cvt_pk_bf16_f32 v101, v25, v34
    v_cvt_pk_bf16_f32 v102, v24, v24
    v_cvt_pk_bf16_f32 v103, v24, v24
    ds_write_b128 v71, v[100:103] offset:12480
    s_cmp_eq_u32 s4, 0
    s_cbranch_scc1 L_nobar_9
    s_sub_u32 s4, s4, 1
    s_barrier
L_nobar_9:
    s_mov_b32 vcc_lo, 0
    s_mov_b32 vcc_hi, 0x80000000
    s_waitcnt lgkmcnt(7)
    v_cndmask_b32 v33, v26, v33, vcc
    v_cndmask_b32 v28, v29, v28, vcc
    v_cndmask_b32 v29, v30, v29, vcc
    v_cvt_pk_bf16_f32 v104, v35, v26
    v_cvt_pk_bf16_f32 v105, v26, v26
    v_cvt_pk_bf16_f32 v106, v26, v26
    v_cvt_pk_bf16_f32 v107, v26, v33
    ds_write_b128 v71, v[104:107] offset:1024
    v_cvt_pk_bf16_f32 v108, v27, v35
    v_cvt_pk_bf16_f32 v109, v26, v26
    v_cvt_pk_bf16_f32 v110, v26, v26
    v_cvt_pk_bf16_f32 v111, v26, v26
    ds_write_b128 v71, v[108:111] offset:5184
    v_cvt_pk_bf16_f32 v88, v27, v27
    v_cvt_pk_bf16_f32 v89, v35, v26
    v_cvt_pk_bf16_f32 v90, v26, v26
    v_cvt_pk_bf16_f32 v91, v26, v26
    ds_write_b128 v71, v[88:91] offset:9344
    v_cvt_pk_bf16_f32 v92, v27, v27
    v_cvt_pk_bf16_f32 v93, v27, v35
    v_cvt_pk_bf16_f32 v94, v26, v26
    v_cvt_pk_bf16_f32 v95, v26, v26
    ds_write_b128 v71, v[92:95] offset:13504
    v_cvt_pk_bf16_f32 v96, v31, v31
    v_cvt_pk_bf16_f32 v97, v30, v30
    v_cvt_pk_bf16_f32 v98, v30, v30
    v_cvt_pk_bf16_f32 v99, v29, v28
    ds_write_b128 v71, v[96:99] offset:2048
    v_cvt_pk_bf16_f32 v100, v31, v31
    v_cvt_pk_bf16_f32 v101, v31, v30
    v_cvt_pk_bf16_f32 v102, v30, v30
    v_cvt_pk_bf16_f32 v103, v30, v29
    ds_write_b128 v71, v[100:103] offset:6208
    v_cvt_pk_bf16_f32 v104, v32, v31
    v_cvt_pk_bf16_f32 v105, v31, v31
    v_cvt_pk_bf16_f32 v106, v30, v30
    v_cvt_pk_bf16_f32 v107, v30, v30
    ds_write_b128 v71, v[104:107] offset:10368
    v_cvt_pk_bf16_f32 v108, v32, v32
    v_cvt_pk_bf16_f32 v109, v31, v31
    v_cvt_pk_bf16_f32 v110, v31, v30
    v_cvt_pk_bf16_f32 v111, v30, v30
    ds_write_b128 v71, v[108:111] offset:14528
    s_cmp_eq_u32 s4, 0
    s_cbranch_scc1 L_nobar_10
    s_sub_u32 s4, s4, 1
    s_barrier
L_nobar_10:
    s_mov_b32 vcc_lo, 0x7fffffff
    s_mov_b32 vcc_hi, 0
    s_waitcnt lgkmcnt(12)
    v_cndmask_b32 v36, v73, v74, vcc
    v_cndmask_b32 v37, v74, v75, vcc
    v_cndmask_b32 v38, v75, v76, vcc
    s_mov_b32 vcc_lo, -1
    v_cndmask_b32 v40, v77, v76, vcc
    v_cndmask_b32 v41, v78, v77, vcc
    v_cndmask_b32 v42, v79, v78, vcc
    v_cndmask_b32 v43, v80, v78, vcc
    v_cndmask_b32 v44, v81, v78, vcc
    v_cndmask_b32 v45, v82, v79, vcc
    v_cndmask_b32 v46, v83, v80, vcc
    s_mov_b32 exec_lo, 0
    s_mov_b32 exec_hi, 0x80000000
    v_mov_b32 v36, 0
    v_mov_b32 v37, 0
    v_mov_b32 v38, 0
    s_mov_b64 exec, -1
    v_cvt_pk_bf16_f32 v88, v43, v42
    v_cvt_pk_bf16_f32 v89, v41, v40
    v_cvt_pk_bf16_f32 v90, v76, v38
    v_cvt_pk_bf16_f32 v91, v37, v36
    ds_write_b128 v71, v[88:91] offset:3072
    v_cvt_pk_bf16_f32 v92, v44, v43
    v_cvt_pk_bf16_f32 v93, v42, v41
    v_cvt_pk_bf16_f32 v94, v40, v76
    v_cvt_pk_bf16_f32 v95, v38, v37
    ds_write_b128 v71, v[92:95] offset:7232
    v_cvt_pk_bf16_f32 v96, v45, v44
    v_cvt_pk_bf16_f32 v97, v43, v42
    v_cvt_pk_bf16_f32 v98, v41, v40
    v_cvt_pk_bf16_f32 v99, v76, v38
    ds_write_b128 v71, v[96:99] offset:11392
    v_cvt_pk_bf16_f32 v100, v46, v45
    v_cvt_pk_bf16_f32 v101, v44, v43
    v_cvt_pk_bf16_f32 v102, v42, v41
    v_cvt_pk_bf16_f32 v103, v40, v76
    ds_write_b128 v71, v[100:103] offset:15552
L_drain:
    s_cmp_eq_u32 s4, 0
    s_cbranch_scc1 L_drained
    s_sub_u32 s4, s4, 1
    s_barrier
    s_branch L_drain
L_idle:
    s_add_u32 s69, s62, s63
    s_and_b32 s69, s69, 3
    s_cmp_eq_u32 s69, 3
    s_cselect_b32 s69, 8, 0
    s_and_b32 s70, s58, 7
    s_add_u32 s69, s69, s70
    s_and_b32 s70, s69, 1
    s_cmp_eq_u32 s70, 0
    s_cselect_b32 s44, s28, s30
    s_cselect_b32 s45, s29, s31
    s_and_b32 s45, s45, 0xffff
    s_mov_b32 s46, 2211840
    s_mul_i32 s71, s63, 27
    s_add_u32 s71, s71, 2
    s_lshr_b32 s71, s71, 2
    s_lshr_b32 s72, s69, 1
    s_add_u32 s71, s71, s72
    s_and_b32 s73, s2, 1
    s_mul_i32 s77, s73, 1105920
    s_lshl_b32 s74, s71, 7
    s_add_u32 s77, s77, s74
    s_mul_i32 s78, s73, 13824
    s_mul_i32 s70, s70, 6912
    s_add_u32 s78, s78, s70
    s_lshl_b32 s74, s71, 8
    s_add_u32 s78, s78, s74
    s_add_u32 s78, s78, 32768
    s_cmp_eq_u32 s63, 2
    s_cselect_b32 s73, 6, 7
    s_cmp_ge_u32 s72, s73
    s_cselect_b32 s77, 1073741824, s77
    s_cselect_b32 s78, 1073741824, s78
    s_and_b32 s70, s2, 7
    s_lshl_b32 s100, s70, 6
    s_add_u32 s100, s100, s69
    v_lshrrev_b32 v16, 3, v0
    v_mul_u32_u24 v16, 3456, v16
    v_and_b32 v17, 7, v0
    v_lshl_add_u32 v8, v17, 4, v16
    v_and_b32 v16, 1, v0
    v_lshlrev_b32 v16, 4, v16
    v_mov_b32 v17, 0x3f80
    v_lshlrev_b32 v17, v16, v17
    v_bfe_u32 v16, v0, 1, 2
    v_cmp_eq_u32 vcc, 0, v16
    s_nop 1
    v_cndmask_b32 v24, 0, v17, vcc
    v_cmp_eq_u32 vcc, 1, v16
    s_nop 1
    v_cndmask_b32 v25, 0, v17, vcc
    v_cmp_eq_u32 vcc, 2, v16
    s_nop 1
    v_cndmask_b32 v26, 0, v17, vcc
    v_cmp_eq_u32 vcc, 3, v16
    s_nop 1
    v_cndmask_b32 v27, 0, v17, vcc
    s_barrier
    s_barrier
    buffer_load_dwordx4 v[64:67], v8, s[44:47], s77 offen
    s_add_u32 s77, s77, 27648
    buffer_load_dwordx4 v[68:71], v8, s[44:47], s77 offen
    s_add_u32 s77, s77, 27648
    buffer_load_dwordx4 v[72:75], v8, s[44:47], s77 offen
    s_add_u32 s77, s77, 27648
    buffer_load_dwordx4 v[76:79], v8, s[44:47], s77 offen
    s_add_u32 s77, s77, 27648
    buffer_load_dwordx4 v[80:83], v8, s[44:47], s77 offen
    s_add_u32 s77, s77, 27648
    buffer_load_dwordx4 v[84:87], v8, s[44:47], s77 offen
    s_add_u32 s77, s77, 27648
    buffer_load_dwordx4 v[88:91], v8, s[44:47], s77 offen
    s_add_u32 s77, s77, 27648
    buffer_load_dwordx4 v[92:95], v8, s[44:47], s77 offen
    s_add_u32 s77, s77, 27648
    s_barrier
    buffer_load_dwordx4 v[96:99], v8, s[44:47], s77 offen
    s_add_u32 s77, s77, 27648
    buffer_load_dwordx4 v[100:103], v8, s[44:47], s77 offen
    s_add_u32 s77, s77, 27648
    buffer_load_dwordx4 v[104:107], v8, s[44:47], s77 offen
    s_add_u32 s77, s77, 27648
    buffer_load_dwordx4 v[108:111], v8, s[44:47], s77 offen
    s_add_u32 s77, s77, 27648
    buffer_load_dwordx4 v[112:115], v8, s[44:47], s77 offen
    s_add_u32 s77, s77, 27648
    buffer_load_dwordx4 v[116:119], v8, s[44:47], s77 offen
    s_add_u32 s77, s77, 27648
    buffer_load_dwordx4 v[120:123], v8, s[44:47], s77 offen
    s_add_u32 s77, s77, 27648
    buffer_load_dwordx4 v[124:127], v8, s[44:47], s77 offen
    s_add_u32 s77, s77, 27648
    s_barrier
    buffer_load_dwordx4 v[128:131], v8, s[44:47], s77 offen
    s_add_u32 s77, s77, 27648
    buffer_load_dwordx4 v[132:135], v8, s[44:47], s77 offen
    s_add_u32 s77, s77, 27648
    buffer_load_dwordx4 v[136:139], v8, s[44:47], s77 offen
    s_add_u32 s77, s77, 27648
    buffer_load_dwordx4 v[140:143], v8, s[44:47], s77 offen
    s_add_u32 s77, s77, 27648
    s_waitcnt vmcnt(12)
    v_mfma_f32_16x16x32_bf16 v[20:23], v[24:27], v[64:67], 0
    v_mfma_f32_16x16x32_bf16 v[20:23], v[24:27], v[68:71], v[20:23]
    v_mfma_f32_16x16x32_bf16 v[20:23], v[24:27], v[72:75], v[20:23]
    v_mfma_f32_16x16x32_bf16 v[20:23], v[24:27], v[76:79], v[20:23]
    v_mfma_f32_16x16x32_bf16 v[20:23], v[24:27], v[80:83], v[20:23]
    v_mfma_f32_16x16x32_bf16 v[20:23], v[24:27], v[84:87], v[20:23]
    v_mfma_f32_16x16x32_bf16 v[20:23], v[24:27], v[88:91], v[20:23]
    v_mfma_f32_16x16x32_bf16 v[20:23], v[24:27], v[92:95], v[20:23]
    buffer_load_dwordx4 v[64:67], v8, s[44:47], s77 offen
    s_add_u32 s77, s77, 27648
    buffer_load_dwordx4 v[68:71], v8, s[44:47], s77 offen
    s_add_u32 s77, s77, 27648
    buffer_load_dwordx4 v[72:75], v8, s[44:47], s77 offen
    s_add_u32 s77, s77, 27648
    buffer_load_dwordx4 v[76:79], v8, s[44:47], s77 offen
    s_add_u32 s77, s77, 27648
    s_barrier
    s_waitcnt vmcnt(8)
    v_mfma_f32_16x16x32_bf16 v[20:23], v[24:27], v[96:99], v[20:23]
    v_mfma_f32_16x16x32_bf16 v[20:23], v[24:27], v[100:103], v[20:23]
    v_mfma_f32_16x16x32_bf16 v[20:23], v[24:27], v[104:107], v[20:23]
    v_mfma_f32_16x16x32_bf16 v[20:23], v[24:27], v[108:111], v[20:23]
    v_mfma_f32_16x16x32_bf16 v[20:23], v[24:27], v[112:115], v[20:23]
    v_mfma_f32_16x16x32_bf16 v[20:23], v[24:27], v[116:119], v[20:23]
    v_mfma_f32_16x16x32_bf16 v[20:23], v[24:27], v[120:123], v[20:23]
    v_mfma_f32_16x16x32_bf16 v[20:23], v[24:27], v[124:127], v[20:23]
    buffer_load_dwordx4 v[80:83], v8, s[44:47], s77 offen
    s_add_u32 s77, s77, 27648
    buffer_load_dwordx4 v[84:87], v8, s[44:47], s77 offen
    s_add_u32 s77, s77, 27648
    buffer_load_dwordx4 v[88:91], v8, s[44:47], s77 offen
    s_add_u32 s77, s77, 27648
    buffer_load_dwordx4 v[92:95], v8, s[44:47], s77 offen
    s_add_u32 s77, s77, 27648
    buffer_load_dwordx4 v[96:99], v8, s[44:47], s77 offen
    s_add_u32 s77, s77, 27648
    buffer_load_dwordx4 v[100:103], v8, s[44:47], s77 offen
    s_add_u32 s77, s77, 27648
    buffer_load_dwordx4 v[104:107], v8, s[44:47], s77 offen
    s_add_u32 s77, s77, 27648
    buffer_load_dwordx4 v[108:111], v8, s[44:47], s77 offen
    s_add_u32 s77, s77, 27648
    s_barrier
    s_waitcnt vmcnt(8)
    v_mfma_f32_16x16x32_bf16 v[20:23], v[24:27], v[128:131], v[20:23]
    v_mfma_f32_16x16x32_bf16 v[20:23], v[24:27], v[132:135], v[20:23]
    v_mfma_f32_16x16x32_bf16 v[20:23], v[24:27], v[136:139], v[20:23]
    v_mfma_f32_16x16x32_bf16 v[20:23], v[24:27], v[140:143], v[20:23]
    v_mfma_f32_16x16x32_bf16 v[20:23], v[24:27], v[64:67], v[20:23]
    v_mfma_f32_16x16x32_bf16 v[20:23], v[24:27], v[68:71], v[20:23]
    v_mfma_f32_16x16x32_bf16 v[20:23], v[24:27], v[72:75], v[20:23]
    v_mfma_f32_16x16x32_bf16 v[20:23], v[24:27], v[76:79], v[20:23]
    buffer_load_dwordx4 v[112:115], v8, s[44:47], s77 offen
    s_add_u32 s77, s77, 27648
    buffer_load_dwordx4 v[116:119], v8, s[44:47], s77 offen
    s_add_u32 s77, s77, 27648
    buffer_load_dwordx4 v[120:123], v8, s[44:47], s77 offen
    s_add_u32 s77, s77, 27648
    buffer_load_dwordx4 v[124:127], v8, s[44:47], s77 offen
    s_add_u32 s77, s77, 27648
    buffer_load_dwordx4 v[128:131], v8, s[44:47], s77 offen
    s_add_u32 s77, s77, 27648
    buffer_load_dwordx4 v[132:135], v8, s[44:47], s77 offen
    s_add_u32 s77, s77, 27648
    buffer_load_dwordx4 v[136:139], v8, s[44:47], s77 offen
    s_add_u32 s77, s77, 27648
    buffer_load_dwordx4 v[140:143], v8, s[44:47], s77 offen
    s_add_u32 s77, s77, 27648
    s_barrier
    s_waitcnt vmcnt(8)
    v_mfma_f32_16x16x32_bf16 v[20:23], v[24:27], v[80:83], v[20:23]
    v_mfma_f32_16x16x32_bf16 v[20:23], v[24:27], v[84:87], v[20:23]
    v_mfma_f32_16x16x32_bf16 v[20:23], v[24:27], v[88:91], v[20:23]
    v_mfma_f32_16x16x32_bf16 v[20:23], v[24:27], v[92:95], v[20:23]
    v_mfma_f32_16x16x32_bf16 v[20:23], v[24:27], v[96:99], v[20:23]
    v_mfma_f32_16x16x32_bf16 v[20:23], v[24:27], v[100:103], v[20:23]
    v_mfma_f32_16x16x32_bf16 v[20:23], v[24:27], v[104:107], v[20:23]
    v_mfma_f32_16x16x32_bf16 v[20:23], v[24:27], v[108:111], v[20:23]
    s_barrier
    s_waitcnt vmcnt(0)
    v_mfma_f32_16x16x32_bf16 v[20:23], v[24:27], v[112:115], v[20:23]
    v_mfma_f32_16x16x32_bf16 v[20:23], v[24:27], v[116:119], v[20:23]
    v_mfma_f32_16x16x32_bf16 v[20:23], v[24:27], v[120:123], v[20:23]
    v_mfma_f32_16x16x32_bf16 v[20:23], v[24:27], v[124:127], v[20:23]
    v_mfma_f32_16x16x32_bf16 v[20:23], v[24:27], v[128:131], v[20:23]
    v_mfma_f32_16x16x32_bf16 v[20:23], v[24:27], v[132:135], v[20:23]
    v_mfma_f32_16x16x32_bf16 v[20:23], v[24:27], v[136:139], v[20:23]
    v_mfma_f32_16x16x32_bf16 v[20:23], v[24:27], v[140:143], v[20:23]
    s_nop 7
    v_add_f32_dpp v20, v20, v20 row_ror:8 row_mask:0xf bank_mask:0xf
    v_add_f32_dpp v21, v21, v21 row_ror:8 row_mask:0xf bank_mask:0xf
    v_add_f32_dpp v22, v22, v22 row_ror:8 row_mask:0xf bank_mask:0xf
    v_add_f32_dpp v23, v23, v23 row_ror:8 row_mask:0xf bank_mask:0xf
    v_and_b32 v16, 7, v0
    v_lshlrev_b32 v16, 5, v16
    v_and_b32 v17, 16, v0
    v_add_u32 v16, v16, v17
    s_mov_b32 exec_lo, 0xff00ff
    s_mov_b32 exec_hi, 0
    buffer_store_dwordx4 v[20:23], v16, s[40:43], s78 offen sc1
    s_mov_b64 exec, -1
    s_barrier
    s_barrier
    s_waitcnt vmcnt(0)
    s_lshl_b32 s69, s100, 2
    s_add_u32 s69, s69, 6208
    v_mov_b32 v152, s66
    v_mov_b32 v153, 0
    s_mov_b64 exec, 1
    buffer_store_dword v152, v153, s[40:43], s69 offen sc0 sc1
    s_mov_b64 exec, -1
    s_barrier
    s_mov_b32 s48, s32
    s_and_b32 s49, s33, 0xffff
    s_mov_b32 s50, 2211840
    s_mov_b32 s51, 0x20000
    s_and_b32 s69, s100, 15
    s_lshr_b32 s70, s100, 6
    s_lshl_b32 s69, s69, 3
    s_add_u32 s69, s69, s70
    s_mul_i32 s79, s69, 17280
    v_lshlrev_b32 v9, 7, v0
    buffer_load_dword v10, v9, s[48:51], s79 offen
    s_add_u32 s79, s79, 8192
    buffer_load_dword v10, v9, s[48:51], s79 offen
    s_add_u32 s79, s79, 896
    buffer_load_dword v10, v9, s[48:51], s79 offen
    s_barrier
    s_mov_b32 s4, 8
L_idle2:
    s_barrier
    s_sub_u32 s4, s4, 1
    s_cmp_lg_u32 s4, 0
    s_cbranch_scc1 L_idle2
    s_branch L_hdone
L_drained:
    v_and_b32 v10, 15, v0
    v_lshrrev_b32 v11, 4, v0
    v_and_b32 v12, 3, v10
    v_sub_u32 v13, v10, v12
    v_lshlrev_b32 v14, 3, v11
    v_sub_u32 v13, v14, v13
    v_add_u32 v13, 236, v13
    v_lshlrev_b32 v13, 1, v13
    v_mul_u32_u24 v12, 4160, v12
    s_mul_i32 s70, s3, 16640
    s_add_u32 s70, s70, 105056
    v_add3_u32 v8, v12, v13, s70
    v_lshlrev_b32 v12, 5, v10
    v_lshl_add_u32 v12, v11, 4, v12
    s_mul_i32 s70, s3, 4640
    s_add_u32 s70, s70, 91616
    v_add_u32 v9, s70, v12
    v_mov_b32 v7, 162752
    s_mov_b32 s76, 262144
    v_mov_b32 v16, 0
    v_mov_b32 v17, 0
    v_mov_b32 v18, 0
    v_mov_b32 v19, 0
    s_nop 1
    v_mfma_f32_32x32x16_bf16 v[192:207], v[16:19], v[16:19], 0
    v_mfma_f32_32x32x16_bf16 v[208:223], v[16:19], v[16:19], 0
L_sw:
    ds_read_b32 v14, v7
    s_waitcnt lgkmcnt(0)
    v_readfirstlane_b32 s67, v14
    s_cmp_eq_u32 s67, 1
    s_cbranch_scc1 L_sw_ok
    s_sub_u32 s76, s76, 1
    s_cmp_lg_u32 s76, 0
    s_cbranch_scc1 L_sw
L_sw_ok:
    ds_read_b128 v[128:131], v9 offset:0
    ds_read_b64 v[64:65], v8 offset:3584
    ds_read_b64 v[66:67], v8 offset:3592
    ds_read_b128 v[132:135], v9 offset:512
    ds_read_b64 v[68:69], v8 offset:3072
    ds_read_b64 v[70:71], v8 offset:3080
    ds_read_b128 v[136:139], v9 offset:1024
    ds_read_b64 v[72:73], v8 offset:2560
    ds_read_b64 v[74:75], v8 offset:2568
    ds_read_b128 v[140:143], v9 offset:1536
    ds_read_b64 v[76:77], v8 offset:2048
    ds_read_b64 v[78:79], v8 offset:2056
    s_waitcnt lgkmcnt(8)
    ds_read_b128 v[144:147], v9 offset:2048
    ds_read_b64 v[80:81], v8 offset:1536
    ds_read_b64 v[82:83], v8 offset:1544
    ds_read_b128 v[148:151], v9 offset:2560
    s_waitcnt lgkmcnt(7)
    ds_read_b64 v[84:85], v8 offset:1024
    ds_read_b64 v[86:87], v8 offset:1032
    ds_read_b128 v[152:155], v9 offset:3072
    ds_read_b64 v[88:89], v8 offset:512
    ds_read_b64 v[90:91], v8 offset:520
    s_waitcnt lgkmcnt(8)
    ds_read_b128 v[156:159], v9 offset:3584
    ds_read_b64 v[92:93], v8 offset:0
    ds_read_b64 v[94:95], v8 offset:8
    s_waitcnt lgkmcnt(0)
    v_subrev_u32 v8, 64, v8
    v_subrev_u32 v9, 64, v9
    s_mov_b32 s74, 4
.p2align 6
L_cv:
    v_mfma_f32_16x16x32_bf16 v[192:195], v[64:67], v[128:131], v[192:195]
    ds_read_b128 v[160:163], v9 offset:0
    v_mfma_f32_16x16x32_bf16 v[196:199], v[64:67], v[132:135], v[196:199]
    ds_read_b64 v[96:97], v8 offset:3584
    v_mfma_f32_16x16x32_bf16 v[196:199], v[68:71], v[128:131], v[196:199]
    ds_read_b64 v[98:99], v8 offset:3592
    v_mfma_f32_16x16x32_bf16 v[200:203], v[68:71], v[132:135], v[200:203]
    ds_read_b128 v[164:167], v9 offset:512
    v_mfma_f32_16x16x32_bf16 v[200:203], v[64:67], v[136:139], v[200:203]
    ds_read_b64 v[100:101], v8 offset:3072
    v_mfma_f32_16x16x32_bf16 v[204:207], v[68:71], v[136:139], v[204:207]
    ds_read_b64 v[102:103], v8 offset:3080
    v_mfma_f32_16x16x32_bf16 v[200:203], v[72:75], v[128:131], v[200:203]
    ds_read_b128 v[168:171], v9 offset:1024
    v_mfma_f32_16x16x32_bf16 v[204:207], v[72:75], v[132:135], v[204:207]
    ds_read_b64 v[104:105], v8 offset:2560
    v_mfma_f32_16x16x32_bf16 v[208:211], v[72:75], v[136:139], v[208:211]
    ds_read_b64 v[106:107], v8 offset:2568
    v_mfma_f32_16x16x32_bf16 v[204:207], v[64:67], v[140:143], v[204:207]
    ds_read_b128 v[172:175], v9 offset:1536
    v_mfma_f32_16x16x32_bf16 v[208:211], v[68:71], v[140:143], v[208:211]
    ds_read_b64 v[108:109], v8 offset:2048
    v_mfma_f32_16x16x32_bf16 v[212:215], v[72:75], v[140:143], v[212:215]
    ds_read_b64 v[110:111], v8 offset:2056
    v_mfma_f32_16x16x32_bf16 v[204:207], v[76:79], v[128:131], v[204:207]
    s_waitcnt lgkmcnt(8)
    ds_read_b128 v[176:179], v9 offset:2048
    v_mfma_f32_16x16x32_bf16 v[208:211], v[76:79], v[132:135], v[208:211]
    ds_read_b64 v[112:113], v8 offset:1536
    v_mfma_f32_16x16x32_bf16 v[212:215], v[76:79], v[136:139], v[212:215]
    ds_read_b64 v[114:115], v8 offset:1544
    v_mfma_f32_16x16x32_bf16 v[216:219], v[76:79], v[140:143], v[216:219]
    ds_read_b128 v[180:183], v9 offset:2560
    v_mfma_f32_16x16x32_bf16 v[208:211], v[64:67], v[144:147], v[208:211]
    s_waitcnt lgkmcnt(7)
    ds_read_b64 v[116:117], v8 offset:1024
    v_mfma_f32_16x16x32_bf16 v[212:215], v[68:71], v[144:147], v[212:215]
    ds_read_b64 v[118:119], v8 offset:1032
    v_mfma_f32_16x16x32_bf16 v[216:219], v[72:75], v[144:147], v[216:219]
    ds_read_b128 v[184:187], v9 offset:3072
    v_mfma_f32_16x16x32_bf16 v[220:223], v[76:79], v[144:147], v[220:223]
    ds_read_b64 v[120:121], v8 offset:512
    v_mfma_f32_16x16x32_bf16 v[208:211], v[80:83], v[128:131], v[208:211]
    ds_read_b64 v[122:123], v8 offset:520
    v_mfma_f32_16x16x32_bf16 v[212:215], v[80:83], v[132:135], v[212:215]
    s_waitcnt lgkmcnt(8)
    ds_read_b128 v[188:191], v9 offset:3584
    v_mfma_f32_16x16x32_bf16 v[216:219], v[80:83], v[136:139], v[216:219]
    ds_read_b64 v[124:125], v8 offset:0
    v_mfma_f32_16x16x32_bf16 v[220:223], v[80:83], v[140:143], v[220:223]
    ds_read_b64 v[126:127], v8 offset:8
    v_mfma_f32_16x16x32_bf16 v[212:215], v[64:67], v[148:151], v[212:215]
    v_mfma_f32_16x16x32_bf16 v[216:219], v[68:71], v[148:151], v[216:219]
    v_mfma_f32_16x16x32_bf16 v[220:223], v[72:75], v[148:151], v[220:223]
    v_mfma_f32_16x16x32_bf16 v[212:215], v[84:87], v[128:131], v[212:215]
    v_mfma_f32_16x16x32_bf16 v[216:219], v[84:87], v[132:135], v[216:219]
    v_mfma_f32_16x16x32_bf16 v[220:223], v[84:87], v[136:139], v[220:223]
    v_mfma_f32_16x16x32_bf16 v[216:219], v[64:67], v[152:155], v[216:219]
    v_mfma_f32_16x16x32_bf16 v[220:223], v[68:71], v[152:155], v[220:223]
    v_mfma_f32_16x16x32_bf16 v[216:219], v[88:91], v[128:131], v[216:219]
    v_mfma_f32_16x16x32_bf16 v[220:223], v[88:91], v[132:135], v[220:223]
    v_mfma_f32_16x16x32_bf16 v[220:223], v[64:67], v[156:159], v[220:223]
    v_mfma_f32_16x16x32_bf16 v[220:223], v[92:95], v[128:131], v[220:223]
    s_waitcnt lgkmcnt(0)
    v_subrev_u32 v8, 64, v8
    v_subrev_u32 v9, 64, v9
    v_mfma_f32_16x16x32_bf16 v[192:195], v[96:99], v[160:163], v[192:195]
    ds_read_b128 v[128:131], v9 offset:0
    v_mfma_f32_16x16x32_bf16 v[196:199], v[96:99], v[164:167], v[196:199]
    ds_read_b64 v[64:65], v8 offset:3584
    v_mfma_f32_16x16x32_bf16 v[196:199], v[100:103], v[160:163], v[196:199]
    ds_read_b64 v[66:67], v8 offset:3592
    v_mfma_f32_16x16x32_bf16 v[200:203], v[100:103], v[164:167], v[200:203]
    ds_read_b128 v[132:135], v9 offset:512
    v_mfma_f32_16x16x32_bf16 v[200:203], v[96:99], v[168:171], v[200:203]
    ds_read_b64 v[68:69], v8 offset:3072
    v_mfma_f32_16x16x32_bf16 v[204:207], v[100:103], v[168:171], v[204:207]
    ds_read_b64 v[70:71], v8 offset:3080
    v_mfma_f32_16x16x32_bf16 v[200:203], v[104:107], v[160:163], v[200:203]
    ds_read_b128 v[136:139], v9 offset:1024
    v_mfma_f32_16x16x32_bf16 v[204:207], v[104:107], v[164:167], v[204:207]
    ds_read_b64 v[72:73], v8 offset:2560
    v_mfma_f32_16x16x32_bf16 v[208:211], v[104:107], v[168:171], v[208:211]
    ds_read_b64 v[74:75], v8 offset:2568
    v_mfma_f32_16x16x32_bf16 v[204:207], v[96:99], v[172:175], v[204:207]
    ds_read_b128 v[140:143], v9 offset:1536
    v_mfma_f32_16x16x32_bf16 v[208:211], v[100:103], v[172:175], v[208:211]
    ds_read_b64 v[76:77], v8 offset:2048
    v_mfma_f32_16x16x32_bf16 v[212:215], v[104:107], v[172:175], v[212:215]
    ds_read_b64 v[78:79], v8 offset:2056
    v_mfma_f32_16x16x32_bf16 v[204:207], v[108:111], v[160:163], v[204:207]
    s_waitcnt lgkmcnt(8)
    ds_read_b128 v[144:147], v9 offset:2048
    v_mfma_f32_16x16x32_bf16 v[208:211], v[108:111], v[164:167], v[208:211]
    ds_read_b64 v[80:81], v8 offset:1536
    v_mfma_f32_16x16x32_bf16 v[212:215], v[108:111], v[168:171], v[212:215]
    ds_read_b64 v[82:83], v8 offset:1544
    v_mfma_f32_16x16x32_bf16 v[216:219], v[108:111], v[172:175], v[216:219]
    ds_read_b128 v[148:151], v9 offset:2560
    v_mfma_f32_16x16x32_bf16 v[208:211], v[96:99], v[176:179], v[208:211]
    s_waitcnt lgkmcnt(7)
    ds_read_b64 v[84:85], v8 offset:1024
    v_mfma_f32_16x16x32_bf16 v[212:215], v[100:103], v[176:179], v[212:215]
    ds_read_b64 v[86:87], v8 offset:1032
    v_mfma_f32_16x16x32_bf16 v[216:219], v[104:107], v[176:179], v[216:219]
    ds_read_b128 v[152:155], v9 offset:3072
    v_mfma_f32_16x16x32_bf16 v[220:223], v[108:111], v[176:179], v[220:223]
    ds_read_b64 v[88:89], v8 offset:512
    v_mfma_f32_16x16x32_bf16 v[208:211], v[112:115], v[160:163], v[208:211]
    ds_read_b64 v[90:91], v8 offset:520
    v_mfma_f32_16x16x32_bf16 v[212:215], v[112:115], v[164:167], v[212:215]
    s_waitcnt lgkmcnt(8)
    ds_read_b128 v[156:159], v9 offset:3584
    v_mfma_f32_16x16x32_bf16 v[216:219], v[112:115], v[168:171], v[216:219]
    ds_read_b64 v[92:93], v8 offset:0
    v_mfma_f32_16x16x32_bf16 v[220:223], v[112:115], v[172:175], v[220:223]
    ds_read_b64 v[94:95], v8 offset:8
    v_mfma_f32_16x16x32_bf16 v[212:215], v[96:99], v[180:183], v[212:215]
    v_mfma_f32_16x16x32_bf16 v[216:219], v[100:103], v[180:183], v[216:219]
    v_mfma_f32_16x16x32_bf16 v[220:223], v[104:107], v[180:183], v[220:223]
    v_mfma_f32_16x16x32_bf16 v[212:215], v[116:119], v[160:163], v[212:215]
    v_mfma_f32_16x16x32_bf16 v[216:219], v[116:119], v[164:167], v[216:219]
    v_mfma_f32_16x16x32_bf16 v[220:223], v[116:119], v[168:171], v[220:223]
    v_mfma_f32_16x16x32_bf16 v[216:219], v[96:99], v[184:187], v[216:219]
    v_mfma_f32_16x16x32_bf16 v[220:223], v[100:103], v[184:187], v[220:223]
    v_mfma_f32_16x16x32_bf16 v[216:219], v[120:123], v[160:163], v[216:219]
    v_mfma_f32_16x16x32_bf16 v[220:223], v[120:123], v[164:167], v[220:223]
    v_mfma_f32_16x16x32_bf16 v[220:223], v[96:99], v[188:191], v[220:223]
    v_mfma_f32_16x16x32_bf16 v[220:223], v[124:127], v[160:163], v[220:223]
    s_waitcnt lgkmcnt(0)
    v_subrev_u32 v8, 64, v8
    v_subrev_u32 v9, 64, v9
    s_sub_u32 s74, s74, 1
    s_cmp_lg_u32 s74, 0
    s_cbranch_scc1 L_cv
    s_lshl_b32 s71, s7, 12
    s_add_u32 s71, s71, 2711552
    v_bfe_u32 v12, v0, 4, 1
    v_lshlrev_b32 v12, 9, v12
    v_lshl_add_u32 v12, v10, 5, v12
    v_lshrrev_b32 v13, 5, v0
    v_lshl_add_u32 v12, v13, 4, v12
    v_cvt_pk_bf16_f32 v224, v192, v193
    v_cvt_pk_bf16_f32 v225, v194, v195
    v_cvt_pk_bf16_f32 v226, v196, v197
    v_cvt_pk_bf16_f32 v227, v198, v199
    s_nop 0
    v_permlane16_swap_b32 v224, v226
    v_permlane16_swap_b32 v225, v227
    buffer_store_dwordx4 v[224:227], v12, s[40:43], s71 offen offset:0 sc1
    v_cvt_pk_bf16_f32 v228, v200, v201
    v_cvt_pk_bf16_f32 v229, v202, v203
    v_cvt_pk_bf16_f32 v230, v204, v205
    v_cvt_pk_bf16_f32 v231, v206, v207
    s_nop 0
    v_permlane16_swap_b32 v228, v230
    v_permlane16_swap_b32 v229, v231
    buffer_store_dwordx4 v[228:231], v12, s[40:43], s71 offen offset:1024 sc1
    v_cvt_pk_bf16_f32 v232, v208, v209
    v_cvt_pk_bf16_f32 v233, v210, v211
    v_cvt_pk_bf16_f32 v234, v212, v213
    v_cvt_pk_bf16_f32 v235, v214, v215
    s_nop 0
    v_permlane16_swap_b32 v232, v234
    v_permlane16_swap_b32 v233, v235
    buffer_store_dwordx4 v[232:235], v12, s[40:43], s71 offen offset:2048 sc1
    v_cvt_pk_bf16_f32 v236, v216, v217
    v_cvt_pk_bf16_f32 v237, v218, v219
    v_cvt_pk_bf16_f32 v238, v220, v221
    v_cvt_pk_bf16_f32 v239, v222, v223
    s_nop 0
    v_permlane16_swap_b32 v236, v238
    v_permlane16_swap_b32 v237, v239
    buffer_store_dwordx4 v[236:239], v12, s[40:43], s71 offen offset:3072 sc1
    s_lshl_b32 s70, s7, 2
    s_add_u32 s70, s70, 12288
    v_mov_b32 v8, s66
    v_mov_b32 v9, 0
    s_waitcnt vmcnt(0)
    s_mov_b64 exec, 1
    buffer_store_dword v8, v9, s[40:43], s70 offen sc0 sc1
    s_mov_b64 exec, -1
L_hdone:
    s_endpgm
L_l_b0:
    s_waitcnt vmcnt(20)
    s_barrier
    s_mov_b32 m0, 74752
    s_nop 0
    buffer_load_dwordx4 v64, s[44:47], s78 offen offset:0 lds
    buffer_load_dwordx4 v65, s[44:47], s78 offen offset:1024 lds
    buffer_load_dwordx4 v66, s[44:47], s78 offen offset:2048 lds
    buffer_load_dwordx4 v67, s[44:47], s78 offen offset:3072 lds
    s_mov_b32 m0, 78848
    s_nop 0
    buffer_load_dwordx4 v68, s[44:47], s78 offen offset:0 lds
    buffer_load_dwordx4 v69, s[44:47], s78 offen offset:1024 lds
    buffer_load_dwordx4 v70, s[44:47], s78 offen offset:2048 lds
    buffer_load_dwordx4 v71, s[44:47], s78 offen offset:3072 lds
    s_mov_b32 m0, 82944
    s_nop 0
    buffer_load_dwordx4 v72, s[44:47], s78 offen offset:0 lds
    buffer_load_dwordx4 v73, s[44:47], s78 offen offset:1024 lds
    buffer_load_dwordx4 v74, s[44:47], s78 offen offset:2048 lds
    buffer_load_dwordx4 v75, s[44:47], s78 offen offset:3072 lds
    s_mov_b32 m0, 87040
    s_nop 0
    buffer_load_dwordx4 v76, s[44:47], s78 offen offset:0 lds
    buffer_load_dwordx4 v77, s[44:47], s78 offen offset:1024 lds
    buffer_load_dwordx4 v78, s[44:47], s78 offen offset:2048 lds
    buffer_load_dwordx4 v79, s[44:47], s78 offen offset:3072 lds
    s_add_u32 s78, s78, 128
    s_cmp_eq_u32 s78, 1280
    s_cselect_b32 s78, 0, s78
    s_mov_b32 m0, 33280
    s_nop 0
    buffer_load_dwordx4 v7, s[48:51], s77 offen offset:2048 lds
    s_mov_b32 m0, 36480
    s_nop 0
    buffer_load_dwordx4 v1, s[52:55], s77 offen offset:0 lds
    buffer_load_dwordx4 v2, s[52:55], s77 offen offset:1024 lds
    buffer_load_dwordx4 v3, s[52:55], s77 offen offset:2048 lds
    buffer_load_dwordx4 v4, s[52:55], s77 offen offset:3072 lds
    s_mov_b32 m0, 40576
    s_nop 0
    buffer_load_dwordx4 v5, s[52:55], s77 offen offset:0 lds
    buffer_load_dwordx4 v6, s[52:55], s77 offen offset:1024 lds
    buffer_load_dwordx4 v7, s[52:55], s77 offen offset:2048 lds
    s_add_u32 s77, s77, 110592
    s_cmp_eq_u32 s77, 2211840
    s_cselect_b32 s77, 0, s77
    s_mov_b32 m0, 43776
    s_nop 0
    buffer_load_dwordx4 v1, s[48:51], s77 offen offset:0 lds
    buffer_load_dwordx4 v2, s[48:51], s77 offen offset:1024 lds
    buffer_load_dwordx4 v3, s[48:51], s77 offen offset:2048 lds
    buffer_load_dwordx4 v4, s[48:51], s77 offen offset:3072 lds
    s_mov_b32 m0, 47872
    s_nop 0
    buffer_load_dwordx4 v5, s[48:51], s77 offen offset:0 lds
    buffer_load_dwordx4 v6, s[48:51], s77 offen offset:1024 lds
    s_waitcnt vmcnt(36)
    s_barrier
    buffer_load_dwordx4 v7, s[48:51], s77 offen offset:2048 lds
    s_mov_b32 m0, 51072
    s_nop 0
    buffer_load_dwordx4 v1, s[52:55], s77 offen offset:0 lds
    buffer_load_dwordx4 v2, s[52:55], s77 offen offset:1024 lds
    buffer_load_dwordx4 v3, s[52:55], s77 offen offset:2048 lds
    buffer_load_dwordx4 v4, s[52:55], s77 offen offset:3072 lds
    s_mov_b32 m0, 55168
    s_nop 0
    buffer_load_dwordx4 v5, s[52:55], s77 offen offset:0 lds
    buffer_load_dwordx4 v6, s[52:55], s77 offen offset:1024 lds
    buffer_load_dwordx4 v7, s[52:55], s77 offen offset:2048 lds
    s_add_u32 s77, s77, 110592
    s_cmp_eq_u32 s77, 2211840
    s_cselect_b32 s77, 0, s77
    s_mov_b32 m0, 0
    s_nop 0
    buffer_load_dwordx4 v1, s[48:51], s77 offen offset:0 lds
    buffer_load_dwordx4 v2, s[48:51], s77 offen offset:1024 lds
    buffer_load_dwordx4 v3, s[48:51], s77 offen offset:2048 lds
    buffer_load_dwordx4 v4, s[48:51], s77 offen offset:3072 lds
    s_mov_b32 m0, 4096
    s_nop 0
    buffer_load_dwordx4 v5, s[48:51], s77 offen offset:0 lds
    buffer_load_dwordx4 v6, s[48:51], s77 offen offset:1024 lds
    buffer_load_dwordx4 v7, s[48:51], s77 offen offset:2048 lds
    s_mov_b32 m0, 7296
    s_nop 0
    buffer_load_dwordx4 v1, s[52:55], s77 offen offset:0 lds
    buffer_load_dwordx4 v2, s[52:55], s77 offen offset:1024 lds
    buffer_load_dwordx4 v3, s[52:55], s77 offen offset:2048 lds
    buffer_load_dwordx4 v4, s[52:55], s77 offen offset:3072 lds
    s_mov_b32 m0, 11392
    s_nop 0
    buffer_load_dwordx4 v5, s[52:55], s77 offen offset:0 lds
    buffer_load_dwordx4 v6, s[52:55], s77 offen offset:1024 lds
    buffer_load_dwordx4 v7, s[52:55], s77 offen offset:2048 lds
    s_add_u32 s77, s77, 110592
    s_cmp_eq_u32 s77, 2211840
    s_cselect_b32 s77, 0, s77
    s_waitcnt vmcnt(28)
    s_barrier
    s_mov_b32 m0, 58368
    s_nop 0
    buffer_load_dwordx4 v64, s[44:47], s78 offen offset:0 lds
    buffer_load_dwordx4 v65, s[44:47], s78 offen offset:1024 lds
    buffer_load_dwordx4 v66, s[44:47], s78 offen offset:2048 lds
    buffer_load_dwordx4 v67, s[44:47], s78 offen offset:3072 lds
    s_mov_b32 m0, 62464
    s_nop 0
    buffer_load_dwordx4 v68, s[44:47], s78 offen offset:0 lds
    buffer_load_dwordx4 v69, s[44:47], s78 offen offset:1024 lds
    buffer_load_dwordx4 v70, s[44:47], s78 offen offset:2048 lds
    buffer_load_dwordx4 v71, s[44:47], s78 offen offset:3072 lds
    s_mov_b32 m0, 66560
    s_nop 0
    buffer_load_dwordx4 v72, s[44:47], s78 offen offset:0 lds
    buffer_load_dwordx4 v73, s[44:47], s78 offen offset:1024 lds
    buffer_load_dwordx4 v74, s[44:47], s78 offen offset:2048 lds
    buffer_load_dwordx4 v75, s[44:47], s78 offen offset:3072 lds
    s_mov_b32 m0, 70656
    s_nop 0
    buffer_load_dwordx4 v76, s[44:47], s78 offen offset:0 lds
    buffer_load_dwordx4 v77, s[44:47], s78 offen offset:1024 lds
    buffer_load_dwordx4 v78, s[44:47], s78 offen offset:2048 lds
    buffer_load_dwordx4 v79, s[44:47], s78 offen offset:3072 lds
    s_add_u32 s78, s78, 128
    s_cmp_eq_u32 s78, 1280
    s_cselect_b32 s78, 0, s78
    s_mov_b32 m0, 14592
    s_nop 0
    buffer_load_dwordx4 v1, s[48:51], s77 offen offset:0 lds
    buffer_load_dwordx4 v2, s[48:51], s77 offen offset:1024 lds
    buffer_load_dwordx4 v3, s[48:51], s77 offen offset:2048 lds
    buffer_load_dwordx4 v4, s[48:51], s77 offen offset:3072 lds
    s_mov_b32 m0, 18688
    s_nop 0
    buffer_load_dwordx4 v5, s[48:51], s77 offen offset:0 lds
    buffer_load_dwordx4 v6, s[48:51], s77 offen offset:1024 lds
    s_waitcnt vmcnt(36)
    s_barrier
    buffer_load_dwordx4 v7, s[48:51], s77 offen offset:2048 lds
    s_mov_b32 m0, 21888
    s_nop 0
    buffer_load_dwordx4 v1, s[52:55], s77 offen offset:0 lds
    buffer_load_dwordx4 v2, s[52:55], s77 offen offset:1024 lds
    buffer_load_dwordx4 v3, s[52:55], s77 offen offset:2048 lds
    buffer_load_dwordx4 v4, s[52:55], s77 offen offset:3072 lds
    s_mov_b32 m0, 25984
    s_nop 0
    buffer_load_dwordx4 v5, s[52:55], s77 offen offset:0 lds
    buffer_load_dwordx4 v6, s[52:55], s77 offen offset:1024 lds
    buffer_load_dwordx4 v7, s[52:55], s77 offen offset:2048 lds
    s_add_u32 s77, s77, 110592
    s_cmp_eq_u32 s77, 2211840
    s_cselect_b32 s77, 0, s77
    s_mov_b32 m0, 29184
    s_nop 0
    buffer_load_dwordx4 v1, s[48:51], s77 offen offset:0 lds
    buffer_load_dwordx4 v2, s[48:51], s77 offen offset:1024 lds
    buffer_load_dwordx4 v3, s[48:51], s77 offen offset:2048 lds
    buffer_load_dwordx4 v4, s[48:51], s77 offen offset:3072 lds
    s_mov_b32 m0, 33280
    s_nop 0
    buffer_load_dwordx4 v5, s[48:51], s77 offen offset:0 lds
    buffer_load_dwordx4 v6, s[48:51], s77 offen offset:1024 lds
    buffer_load_dwordx4 v7, s[48:51], s77 offen offset:2048 lds
    s_mov_b32 m0, 36480
    s_nop 0
    buffer_load_dwordx4 v1, s[52:55], s77 offen offset:0 lds
    buffer_load_dwordx4 v2, s[52:55], s77 offen offset:1024 lds
    buffer_load_dwordx4 v3, s[52:55], s77 offen offset:2048 lds
    buffer_load_dwordx4 v4, s[52:55], s77 offen offset:3072 lds
    s_mov_b32 m0, 40576
    s_nop 0
    buffer_load_dwordx4 v5, s[52:55], s77 offen offset:0 lds
    buffer_load_dwordx4 v6, s[52:55], s77 offen offset:1024 lds
    buffer_load_dwordx4 v7, s[52:55], s77 offen offset:2048 lds
    s_add_u32 s77, s77, 110592
    s_cmp_eq_u32 s77, 2211840
    s_cselect_b32 s77, 0, s77
    s_waitcnt vmcnt(28)
    s_barrier
    s_mov_b32 m0, 74752
    s_nop 0
    buffer_load_dwordx4 v64, s[44:47], s78 offen offset:0 lds
    buffer_load_dwordx4 v65, s[44:47], s78 offen offset:1024 lds
    buffer_load_dwordx4 v66, s[44:47], s78 offen offset:2048 lds
    buffer_load_dwordx4 v67, s[44:47], s78 offen offset:3072 lds
    s_mov_b32 m0, 78848
    s_nop 0
    buffer_load_dwordx4 v68, s[44:47], s78 offen offset:0 lds
    buffer_load_dwordx4 v69, s[44:47], s78 offen offset:1024 lds
    buffer_load_dwordx4 v70, s[44:47], s78 offen offset:2048 lds
    buffer_load_dwordx4 v71, s[44:47], s78 offen offset:3072 lds
    s_mov_b32 m0, 82944
    s_nop 0
    buffer_load_dwordx4 v72, s[44:47], s78 offen offset:0 lds
    buffer_load_dwordx4 v73, s[44:47], s78 offen offset:1024 lds
    buffer_load_dwordx4 v74, s[44:47], s78 offen offset:2048 lds
    buffer_load_dwordx4 v75, s[44:47], s78 offen offset:3072 lds
    s_mov_b32 m0, 87040
    s_nop 0
    buffer_load_dwordx4 v76, s[44:47], s78 offen offset:0 lds
    buffer_load_dwordx4 v77, s[44:47], s78 offen offset:1024 lds
    buffer_load_dwordx4 v78, s[44:47], s78 offen offset:2048 lds
    buffer_load_dwordx4 v79, s[44:47], s78 offen offset:3072 lds
    s_add_u32 s78, s78, 128
    s_cmp_eq_u32 s78, 1280
    s_cselect_b32 s78, 0, s78
    s_mov_b32 m0, 43776
    s_nop 0
    buffer_load_dwordx4 v1, s[48:51], s77 offen offset:0 lds
    buffer_load_dwordx4 v2, s[48:51], s77 offen offset:1024 lds
    buffer_load_dwordx4 v3, s[48:51], s77 offen offset:2048 lds
    buffer_load_dwordx4 v4, s[48:51], s77 offen offset:3072 lds
    s_mov_b32 m0, 47872
    s_nop 0
    buffer_load_dwordx4 v5, s[48:51], s77 offen offset:0 lds
    buffer_load_dwordx4 v6, s[48:51], s77 offen offset:1024 lds
    s_waitcnt vmcnt(36)
    s_barrier
    buffer_load_dwordx4 v7, s[48:51], s77 offen offset:2048 lds
    s_mov_b32 m0, 51072
    s_nop 0
    buffer_load_dwordx4 v1, s[52:55], s77 offen offset:0 lds
    buffer_load_dwordx4 v2, s[52:55], s77 offen offset:1024 lds
    buffer_load_dwordx4 v3, s[52:55], s77 offen offset:2048 lds
    buffer_load_dwordx4 v4, s[52:55], s77 offen offset:3072 lds
    s_mov_b32 m0, 55168
    s_nop 0
    buffer_load_dwordx4 v5, s[52:55], s77 offen offset:0 lds
    buffer_load_dwordx4 v6, s[52:55], s77 offen offset:1024 lds
    buffer_load_dwordx4 v7, s[52:55], s77 offen offset:2048 lds
    s_add_u32 s77, s77, 110592
    s_cmp_eq_u32 s77, 2211840
    s_cselect_b32 s77, 0, s77
    s_mov_b32 m0, 0
    s_nop 0
    buffer_load_dwordx4 v1, s[48:51], s77 offen offset:0 lds
    buffer_load_dwordx4 v2, s[48:51], s77 offen offset:1024 lds
    buffer_load_dwordx4 v3, s[48:51], s77 offen offset:2048 lds
    buffer_load_dwordx4 v4, s[48:51], s77 offen offset:3072 lds
    s_mov_b32 m0, 4096
    s_nop 0
    buffer_load_dwordx4 v5, s[48:51], s77 offen offset:0 lds
    buffer_load_dwordx4 v6, s[48:51], s77 offen offset:1024 lds
    buffer_load_dwordx4 v7, s[48:51], s77 offen offset:2048 lds
    s_mov_b32 m0, 7296
    s_nop 0
    buffer_load_dwordx4 v1, s[52:55], s77 offen offset:0 lds
    buffer_load_dwordx4 v2, s[52:55], s77 offen offset:1024 lds
    buffer_load_dwordx4 v3, s[52:55], s77 offen offset:2048 lds
    buffer_load_dwordx4 v4, s[52:55], s77 offen offset:3072 lds
    s_mov_b32 m0, 11392
    s_nop 0
    buffer_load_dwordx4 v5, s[52:55], s77 offen offset:0 lds
    buffer_load_dwordx4 v6, s[52:55], s77 offen offset:1024 lds
    buffer_load_dwordx4 v7, s[52:55], s77 offen offset:2048 lds
    s_add_u32 s77, s77, 110592
    s_cmp_eq_u32 s77, 2211840
    s_cselect_b32 s77, 0, s77
    s_waitcnt vmcnt(28)
    s_barrier
    s_mov_b32 m0, 58368
    s_nop 0
    buffer_load_dwordx4 v64, s[44:47], s78 offen offset:0 lds
    buffer_load_dwordx4 v65, s[44:47], s78 offen offset:1024 lds
    buffer_load_dwordx4 v66, s[44:47], s78 offen offset:2048 lds
    buffer_load_dwordx4 v67, s[44:47], s78 offen offset:3072 lds
    s_mov_b32 m0, 62464
    s_nop 0
    buffer_load_dwordx4 v68, s[44:47], s78 offen offset:0 lds
    buffer_load_dwordx4 v69, s[44:47], s78 offen offset:1024 lds
    buffer_load_dwordx4 v70, s[44:47], s78 offen offset:2048 lds
    buffer_load_dwordx4 v71, s[44:47], s78 offen offset:3072 lds
    s_mov_b32 m0, 66560
    s_nop 0
    buffer_load_dwordx4 v72, s[44:47], s78 offen offset:0 lds
    buffer_load_dwordx4 v73, s[44:47], s78 offen offset:1024 lds
    buffer_load_dwordx4 v74, s[44:47], s78 offen offset:2048 lds
    buffer_load_dwordx4 v75, s[44:47], s78 offen offset:3072 lds
    s_mov_b32 m0, 70656
    s_nop 0
    buffer_load_dwordx4 v76, s[44:47], s78 offen offset:0 lds
    buffer_load_dwordx4 v77, s[44:47], s78 offen offset:1024 lds
    buffer_load_dwordx4 v78, s[44:47], s78 offen offset:2048 lds
    buffer_load_dwordx4 v79, s[44:47], s78 offen offset:3072 lds
    s_add_u32 s78, s78, 128
    s_cmp_eq_u32 s78, 1280
    s_cselect_b32 s78, 0, s78
    s_mov_b32 m0, 14592
    s_nop 0
    buffer_load_dwordx4 v1, s[48:51], s77 offen offset:0 lds
    buffer_load_dwordx4 v2, s[48:51], s77 offen offset:1024 lds
    buffer_load_dwordx4 v3, s[48:51], s77 offen offset:2048 lds
    buffer_load_dwordx4 v4, s[48:51], s77 offen offset:3072 lds
    s_mov_b32 m0, 18688
    s_nop 0
    buffer_load_dwordx4 v5, s[48:51], s77 offen offset:0 lds
    buffer_load_dwordx4 v6, s[48:51], s77 offen offset:1024 lds
    s_waitcnt vmcnt(36)
    s_barrier
    s_lshl_b32 s70, s2, 2
    s_add_u32 s70, s70, 4096
    v_mov_b32 v152, s66
    v_mov_b32 v153, 0
    s_mov_b64 exec, 1
    buffer_store_dword v152, v153, s[40:43], s70 offen sc0 sc1
    s_mov_b64 exec, -1
    buffer_load_dwordx4 v7, s[48:51], s77 offen offset:2048 lds
    s_mov_b32 m0, 21888
    s_nop 0
    buffer_load_dwordx4 v1, s[52:55], s77 offen offset:0 lds
    buffer_load_dwordx4 v2, s[52:55], s77 offen offset:1024 lds
    buffer_load_dwordx4 v3, s[52:55], s77 offen offset:2048 lds
    buffer_load_dwordx4 v4, s[52:55], s77 offen offset:3072 lds
    s_mov_b32 m0, 25984
    s_nop 0
    buffer_load_dwordx4 v5, s[52:55], s77 offen offset:0 lds
    buffer_load_dwordx4 v6, s[52:55], s77 offen offset:1024 lds
    buffer_load_dwordx4 v7, s[52:55], s77 offen offset:2048 lds
    s_add_u32 s77, s77, 110592
    s_cmp_eq_u32 s77, 2211840
    s_cselect_b32 s77, 0, s77
    s_mov_b32 m0, 29184
    s_nop 0
    buffer_load_dwordx4 v1, s[48:51], s77 offen offset:0 lds
    buffer_load_dwordx4 v2, s[48:51], s77 offen offset:1024 lds
    buffer_load_dwordx4 v3, s[48:51], s77 offen offset:2048 lds
    buffer_load_dwordx4 v4, s[48:51], s77 offen offset:3072 lds
    s_mov_b32 m0, 33280
    s_nop 0
    buffer_load_dwordx4 v5, s[48:51], s77 offen offset:0 lds
    buffer_load_dwordx4 v6, s[48:51], s77 offen offset:1024 lds
    buffer_load_dwordx4 v7, s[48:51], s77 offen offset:2048 lds
    s_mov_b32 m0, 36480
    s_nop 0
    buffer_load_dwordx4 v1, s[52:55], s77 offen offset:0 lds
    buffer_load_dwordx4 v2, s[52:55], s77 offen offset:1024 lds
    buffer_load_dwordx4 v3, s[52:55], s77 offen offset:2048 lds
    buffer_load_dwordx4 v4, s[52:55], s77 offen offset:3072 lds
    s_mov_b32 m0, 40576
    s_nop 0
    buffer_load_dwordx4 v5, s[52:55], s77 offen offset:0 lds
    buffer_load_dwordx4 v6, s[52:55], s77 offen offset:1024 lds
    buffer_load_dwordx4 v7, s[52:55], s77 offen offset:2048 lds
    s_add_u32 s77, s77, 110592
    s_cmp_eq_u32 s77, 2211840
    s_cselect_b32 s77, 0, s77
    s_waitcnt vmcnt(29)
    s_barrier
    s_mov_b32 m0, 74752
    s_nop 0
    buffer_load_dwordx4 v64, s[44:47], s78 offen offset:0 lds
    buffer_load_dwordx4 v65, s[44:47], s78 offen offset:1024 lds
    buffer_load_dwordx4 v66, s[44:47], s78 offen offset:2048 lds
    buffer_load_dwordx4 v67, s[44:47], s78 offen offset:3072 lds
    s_mov_b32 m0, 78848
    s_nop 0
    buffer_load_dwordx4 v68, s[44:47], s78 offen offset:0 lds
    buffer_load_dwordx4 v69, s[44:47], s78 offen offset:1024 lds
    buffer_load_dwordx4 v70, s[44:47], s78 offen offset:2048 lds
    buffer_load_dwordx4 v71, s[44:47], s78 offen offset:3072 lds
    s_mov_b32 m0, 82944
    s_nop 0
    buffer_load_dwordx4 v72, s[44:47], s78 offen offset:0 lds
    buffer_load_dwordx4 v73, s[44:47], s78 offen offset:1024 lds
    buffer_load_dwordx4 v74, s[44:47], s78 offen offset:2048 lds
    buffer_load_dwordx4 v75, s[44:47], s78 offen offset:3072 lds
    s_mov_b32 m0, 87040
    s_nop 0
    buffer_load_dwordx4 v76, s[44:47], s78 offen offset:0 lds
    buffer_load_dwordx4 v77, s[44:47], s78 offen offset:1024 lds
    buffer_load_dwordx4 v78, s[44:47], s78 offen offset:2048 lds
    buffer_load_dwordx4 v79, s[44:47], s78 offen offset:3072 lds
    s_add_u32 s78, s78, 128
    s_cmp_eq_u32 s78, 1280
    s_cselect_b32 s78, 0, s78
    s_mov_b32 m0, 43776
    s_nop 0
    buffer_load_dwordx4 v1, s[48:51], s77 offen offset:0 lds
    buffer_load_dwordx4 v2, s[48:51], s77 offen offset:1024 lds
    buffer_load_dwordx4 v3, s[48:51], s77 offen offset:2048 lds
    buffer_load_dwordx4 v4, s[48:51], s77 offen offset:3072 lds
    s_mov_b32 m0, 47872
    s_nop 0
    buffer_load_dwordx4 v5, s[48:51], s77 offen offset:0 lds
    buffer_load_dwordx4 v6, s[48:51], s77 offen offset:1024 lds
    s_waitcnt vmcnt(36)
    s_barrier
    buffer_load_dwordx4 v7, s[48:51], s77 offen offset:2048 lds
    s_mov_b32 m0, 51072
    s_nop 0
    buffer_load_dwordx4 v1, s[52:55], s77 offen offset:0 lds
    buffer_load_dwordx4 v2, s[52:55], s77 offen offset:1024 lds
    buffer_load_dwordx4 v3, s[52:55], s77 offen offset:2048 lds
    buffer_load_dwordx4 v4, s[52:55], s77 offen offset:3072 lds
    s_mov_b32 m0, 55168
    s_nop 0
    buffer_load_dwordx4 v5, s[52:55], s77 offen offset:0 lds
    buffer_load_dwordx4 v6, s[52:55], s77 offen offset:1024 lds
    buffer_load_dwordx4 v7, s[52:55], s77 offen offset:2048 lds
    s_add_u32 s77, s77, 110592
    s_cmp_eq_u32 s77, 2211840
    s_cselect_b32 s77, 0, s77
    s_mov_b32 m0, 0
    s_nop 0
    buffer_load_dwordx4 v1, s[48:51], s77 offen offset:0 lds
    buffer_load_dwordx4 v2, s[48:51], s77 offen offset:1024 lds
    buffer_load_dwordx4 v3, s[48:51], s77 offen offset:2048 lds
    buffer_load_dwordx4 v4, s[48:51], s77 offen offset:3072 lds
    s_mov_b32 m0, 4096
    s_nop 0
    buffer_load_dwordx4 v5, s[48:51], s77 offen offset:0 lds
    buffer_load_dwordx4 v6, s[48:51], s77 offen offset:1024 lds
    buffer_load_dwordx4 v7, s[48:51], s77 offen offset:2048 lds
    s_mov_b32 m0, 7296
    s_nop 0
    buffer_load_dwordx4 v1, s[52:55], s77 offen offset:0 lds
    buffer_load_dwordx4 v2, s[52:55], s77 offen offset:1024 lds
    buffer_load_dwordx4 v3, s[52:55], s77 offen offset:2048 lds
    buffer_load_dwordx4 v4, s[52:55], s77 offen offset:3072 lds
    s_mov_b32 m0, 11392
    s_nop 0
    buffer_load_dwordx4 v5, s[52:55], s77 offen offset:0 lds
    buffer_load_dwordx4 v6, s[52:55], s77 offen offset:1024 lds
    buffer_load_dwordx4 v7, s[52:55], s77 offen offset:2048 lds
    s_add_u32 s77, s77, 110592
    s_cmp_eq_u32 s77, 2211840
    s_cselect_b32 s77, 0, s77
    s_waitcnt vmcnt(28)
    s_barrier
    s_mov_b32 m0, 58368
    s_nop 0
    buffer_load_dwordx4 v64, s[44:47], s78 offen offset:0 lds
    buffer_load_dwordx4 v65, s[44:47], s78 offen offset:1024 lds
    buffer_load_dwordx4 v66, s[44:47], s78 offen offset:2048 lds
    buffer_load_dwordx4 v67, s[44:47], s78 offen offset:3072 lds
    s_mov_b32 m0, 62464
    s_nop 0
    buffer_load_dwordx4 v68, s[44:47], s78 offen offset:0 lds
    buffer_load_dwordx4 v69, s[44:47], s78 offen offset:1024 lds
    buffer_load_dwordx4 v70, s[44:47], s78 offen offset:2048 lds
    buffer_load_dwordx4 v71, s[44:47], s78 offen offset:3072 lds
    s_mov_b32 m0, 66560
    s_nop 0
    buffer_load_dwordx4 v72, s[44:47], s78 offen offset:0 lds
    buffer_load_dwordx4 v73, s[44:47], s78 offen offset:1024 lds
    buffer_load_dwordx4 v74, s[44:47], s78 offen offset:2048 lds
    buffer_load_dwordx4 v75, s[44:47], s78 offen offset:3072 lds
    s_mov_b32 m0, 70656
    s_nop 0
    buffer_load_dwordx4 v76, s[44:47], s78 offen offset:0 lds
    buffer_load_dwordx4 v77, s[44:47], s78 offen offset:1024 lds
    buffer_load_dwordx4 v78, s[44:47], s78 offen offset:2048 lds
    buffer_load_dwordx4 v79, s[44:47], s78 offen offset:3072 lds
    s_add_u32 s78, s78, 128
    s_cmp_eq_u32 s78, 1280
    s_cselect_b32 s78, 0, s78
    s_mov_b32 m0, 14592
    s_nop 0
    buffer_load_dwordx4 v1, s[48:51], s77 offen offset:0 lds
    buffer_load_dwordx4 v2, s[48:51], s77 offen offset:1024 lds
    buffer_load_dwordx4 v3, s[48:51], s77 offen offset:2048 lds
    buffer_load_dwordx4 v4, s[48:51], s77 offen offset:3072 lds
    s_mov_b32 m0, 18688
    s_nop 0
    buffer_load_dwordx4 v5, s[48:51], s77 offen offset:0 lds
    buffer_load_dwordx4 v6, s[48:51], s77 offen offset:1024 lds
    s_waitcnt vmcnt(36)
    s_barrier
    buffer_load_dwordx4 v7, s[48:51], s77 offen offset:2048 lds
    s_mov_b32 m0, 21888
    s_nop 0
    buffer_load_dwordx4 v1, s[52:55], s77 offen offset:0 lds
    buffer_load_dwordx4 v2, s[52:55], s77 offen offset:1024 lds
    buffer_load_dwordx4 v3, s[52:55], s77 offen offset:2048 lds
    buffer_load_dwordx4 v4, s[52:55], s77 offen offset:3072 lds
    s_mov_b32 m0, 25984
    s_nop 0
    buffer_load_dwordx4 v5, s[52:55], s77 offen offset:0 lds
    buffer_load_dwordx4 v6, s[52:55], s77 offen offset:1024 lds
    buffer_load_dwordx4 v7, s[52:55], s77 offen offset:2048 lds
    s_add_u32 s77, s77, 110592
    s_cmp_eq_u32 s77, 2211840
    s_cselect_b32 s77, 0, s77
    s_mov_b32 m0, 29184
    s_nop 0
    buffer_load_dwordx4 v1, s[48:51], s77 offen offset:0 lds
    buffer_load_dwordx4 v2, s[48:51], s77 offen offset:1024 lds
    buffer_load_dwordx4 v3, s[48:51], s77 offen offset:2048 lds
    buffer_load_dwordx4 v4, s[48:51], s77 offen offset:3072 lds
    s_mov_b32 m0, 33280
    s_nop 0
    buffer_load_dwordx4 v5, s[48:51], s77 offen offset:0 lds
    buffer_load_dwordx4 v6, s[48:51], s77 offen offset:1024 lds
    buffer_load_dwordx4 v7, s[48:51], s77 offen offset:2048 lds
    s_mov_b32 m0, 36480
    s_nop 0
    buffer_load_dwordx4 v1, s[52:55], s77 offen offset:0 lds
    buffer_load_dwordx4 v2, s[52:55], s77 offen offset:1024 lds
    buffer_load_dwordx4 v3, s[52:55], s77 offen offset:2048 lds
    buffer_load_dwordx4 v4, s[52:55], s77 offen offset:3072 lds
    s_mov_b32 m0, 40576
    s_nop 0
    buffer_load_dwordx4 v5, s[52:55], s77 offen offset:0 lds
    buffer_load_dwordx4 v6, s[52:55], s77 offen offset:1024 lds
    buffer_load_dwordx4 v7, s[52:55], s77 offen offset:2048 lds
    s_add_u32 s77, s77, 110592
    s_cmp_eq_u32 s77, 2211840
    s_cselect_b32 s77, 0, s77
    s_waitcnt vmcnt(28)
    s_barrier
    s_mov_b32 m0, 74752
    s_nop 0
    buffer_load_dwordx4 v64, s[44:47], s78 offen offset:0 lds
    buffer_load_dwordx4 v65, s[44:47], s78 offen offset:1024 lds
    buffer_load_dwordx4 v66, s[44:47], s78 offen offset:2048 lds
    buffer_load_dwordx4 v67, s[44:47], s78 offen offset:3072 lds
    s_mov_b32 m0, 78848
    s_nop 0
    buffer_load_dwordx4 v68, s[44:47], s78 offen offset:0 lds
    buffer_load_dwordx4 v69, s[44:47], s78 offen offset:1024 lds
    buffer_load_dwordx4 v70, s[44:47], s78 offen offset:2048 lds
    buffer_load_dwordx4 v71, s[44:47], s78 offen offset:3072 lds
    s_mov_b32 m0, 82944
    s_nop 0
    buffer_load_dwordx4 v72, s[44:47], s78 offen offset:0 lds
    buffer_load_dwordx4 v73, s[44:47], s78 offen offset:1024 lds
    buffer_load_dwordx4 v74, s[44:47], s78 offen offset:2048 lds
    buffer_load_dwordx4 v75, s[44:47], s78 offen offset:3072 lds
    s_mov_b32 m0, 87040
    s_nop 0
    buffer_load_dwordx4 v76, s[44:47], s78 offen offset:0 lds
    buffer_load_dwordx4 v77, s[44:47], s78 offen offset:1024 lds
    buffer_load_dwordx4 v78, s[44:47], s78 offen offset:2048 lds
    buffer_load_dwordx4 v79, s[44:47], s78 offen offset:3072 lds
    s_add_u32 s78, s78, 128
    s_cmp_eq_u32 s78, 1280
    s_cselect_b32 s78, 0, s78
    s_mov_b32 m0, 43776
    s_nop 0
    buffer_load_dwordx4 v1, s[48:51], s77 offen offset:0 lds
    buffer_load_dwordx4 v2, s[48:51], s77 offen offset:1024 lds
    buffer_load_dwordx4 v3, s[48:51], s77 offen offset:2048 lds
    buffer_load_dwordx4 v4, s[48:51], s77 offen offset:3072 lds
    s_mov_b32 m0, 47872
    s_nop 0
    buffer_load_dwordx4 v5, s[48:51], s77 offen offset:0 lds
    buffer_load_dwordx4 v6, s[48:51], s77 offen offset:1024 lds
    s_waitcnt vmcnt(36)
    s_barrier
    buffer_load_dwordx4 v7, s[48:51], s77 offen offset:2048 lds
    s_mov_b32 m0, 51072
    s_nop 0
    buffer_load_dwordx4 v1, s[52:55], s77 offen offset:0 lds
    buffer_load_dwordx4 v2, s[52:55], s77 offen offset:1024 lds
    buffer_load_dwordx4 v3, s[52:55], s77 offen offset:2048 lds
    buffer_load_dwordx4 v4, s[52:55], s77 offen offset:3072 lds
    s_mov_b32 m0, 55168
    s_nop 0
    buffer_load_dwordx4 v5, s[52:55], s77 offen offset:0 lds
    buffer_load_dwordx4 v6, s[52:55], s77 offen offset:1024 lds
    buffer_load_dwordx4 v7, s[52:55], s77 offen offset:2048 lds
    s_add_u32 s77, s77, 110592
    s_cmp_eq_u32 s77, 2211840
    s_cselect_b32 s77, 0, s77
    s_mov_b32 m0, 0
    s_nop 0
    buffer_load_dwordx4 v1, s[48:51], s77 offen offset:0 lds
    buffer_load_dwordx4 v2, s[48:51], s77 offen offset:1024 lds
    buffer_load_dwordx4 v3, s[48:51], s77 offen offset:2048 lds
    buffer_load_dwordx4 v4, s[48:51], s77 offen offset:3072 lds
    s_mov_b32 m0, 4096
    s_nop 0
    buffer_load_dwordx4 v5, s[48:51], s77 offen offset:0 lds
    buffer_load_dwordx4 v6, s[48:51], s77 offen offset:1024 lds
    buffer_load_dwordx4 v7, s[48:51], s77 offen offset:2048 lds
    s_mov_b32 m0, 7296
    s_nop 0
    buffer_load_dwordx4 v1, s[52:55], s77 offen offset:0 lds
    buffer_load_dwordx4 v2, s[52:55], s77 offen offset:1024 lds
    buffer_load_dwordx4 v3, s[52:55], s77 offen offset:2048 lds
    buffer_load_dwordx4 v4, s[52:55], s77 offen offset:3072 lds
    s_mov_b32 m0, 11392
    s_nop 0
    buffer_load_dwordx4 v5, s[52:55], s77 offen offset:0 lds
    buffer_load_dwordx4 v6, s[52:55], s77 offen offset:1024 lds
    buffer_load_dwordx4 v7, s[52:55], s77 offen offset:2048 lds
    s_add_u32 s77, s77, 110592
    s_cmp_eq_u32 s77, 2211840
    s_cselect_b32 s77, 0, s77
    s_waitcnt vmcnt(28)
    s_barrier
    s_mov_b32 m0, 58368
    s_nop 0
    buffer_load_dwordx4 v64, s[44:47], s78 offen offset:0 lds
    buffer_load_dwordx4 v65, s[44:47], s78 offen offset:1024 lds
    buffer_load_dwordx4 v66, s[44:47], s78 offen offset:2048 lds
    buffer_load_dwordx4 v67, s[44:47], s78 offen offset:3072 lds
    s_mov_b32 m0, 62464
    s_nop 0
    buffer_load_dwordx4 v68, s[44:47], s78 offen offset:0 lds
    buffer_load_dwordx4 v69, s[44:47], s78 offen offset:1024 lds
    buffer_load_dwordx4 v70, s[44:47], s78 offen offset:2048 lds
    buffer_load_dwordx4 v71, s[44:47], s78 offen offset:3072 lds
    s_mov_b32 m0, 66560
    s_nop 0
    buffer_load_dwordx4 v72, s[44:47], s78 offen offset:0 lds
    buffer_load_dwordx4 v73, s[44:47], s78 offen offset:1024 lds
    buffer_load_dwordx4 v74, s[44:47], s78 offen offset:2048 lds
    buffer_load_dwordx4 v75, s[44:47], s78 offen offset:3072 lds
    s_mov_b32 m0, 70656
    s_nop 0
    buffer_load_dwordx4 v76, s[44:47], s78 offen offset:0 lds
    buffer_load_dwordx4 v77, s[44:47], s78 offen offset:1024 lds
    buffer_load_dwordx4 v78, s[44:47], s78 offen offset:2048 lds
    buffer_load_dwordx4 v79, s[44:47], s78 offen offset:3072 lds
    s_add_u32 s78, s78, 128
    s_cmp_eq_u32 s78, 1280
    s_cselect_b32 s78, 0, s78
    s_mov_b32 m0, 14592
    s_nop 0
    buffer_load_dwordx4 v1, s[48:51], s77 offen offset:0 lds
    buffer_load_dwordx4 v2, s[48:51], s77 offen offset:1024 lds
    buffer_load_dwordx4 v3, s[48:51], s77 offen offset:2048 lds
    buffer_load_dwordx4 v4, s[48:51], s77 offen offset:3072 lds
    s_mov_b32 m0, 18688
    s_nop 0
    buffer_load_dwordx4 v5, s[48:51], s77 offen offset:0 lds
    buffer_load_dwordx4 v6, s[48:51], s77 offen offset:1024 lds
    s_waitcnt vmcnt(36)
    s_barrier
    s_mov_b32 s70, 4096
    s_mov_b32 s72, 6208
    v_lshrrev_b32 v60, 3, v0
    v_and_b32 v61, 7, v0
    v_lshlrev_b32 v61, 3, v61
    v_lshl_add_u32 v60, v60, 8, v61
    buffer_load_dwordx4 v[148:151], v59, s[40:43], s70 offen sc1
    buffer_load_dwordx2 v[154:155], v60, s[40:43], s72 offen sc1
    buffer_load_dwordx4 v7, s[48:51], s77 offen offset:2048 lds
    s_mov_b32 m0, 21888
    s_nop 0
    buffer_load_dwordx4 v1, s[52:55], s77 offen offset:0 lds
    buffer_load_dwordx4 v2, s[52:55], s77 offen offset:1024 lds
    buffer_load_dwordx4 v3, s[52:55], s77 offen offset:2048 lds
    buffer_load_dwordx4 v4, s[52:55], s77 offen offset:3072 lds
    s_mov_b32 m0, 25984
    s_nop 0
    buffer_load_dwordx4 v5, s[52:55], s77 offen offset:0 lds
    buffer_load_dwordx4 v6, s[52:55], s77 offen offset:1024 lds
    buffer_load_dwordx4 v7, s[52:55], s77 offen offset:2048 lds
    s_add_u32 s77, s77, 110592
    s_cmp_eq_u32 s77, 2211840
    s_cselect_b32 s77, 0, s77
    s_mov_b32 m0, 29184
    s_nop 0
    buffer_load_dwordx4 v1, s[48:51], s77 offen offset:0 lds
    buffer_load_dwordx4 v2, s[48:51], s77 offen offset:1024 lds
    buffer_load_dwordx4 v3, s[48:51], s77 offen offset:2048 lds
    buffer_load_dwordx4 v4, s[48:51], s77 offen offset:3072 lds
    s_mov_b32 m0, 33280
    s_nop 0
    buffer_load_dwordx4 v5, s[48:51], s77 offen offset:0 lds
    buffer_load_dwordx4 v6, s[48:51], s77 offen offset:1024 lds
    buffer_load_dwordx4 v7, s[48:51], s77 offen offset:2048 lds
    s_mov_b32 m0, 36480
    s_nop 0
    buffer_load_dwordx4 v1, s[52:55], s77 offen offset:0 lds
    buffer_load_dwordx4 v2, s[52:55], s77 offen offset:1024 lds
    buffer_load_dwordx4 v3, s[52:55], s77 offen offset:2048 lds
    buffer_load_dwordx4 v4, s[52:55], s77 offen offset:3072 lds
    s_mov_b32 m0, 40576
    s_nop 0
    buffer_load_dwordx4 v5, s[52:55], s77 offen offset:0 lds
    buffer_load_dwordx4 v6, s[52:55], s77 offen offset:1024 lds
    buffer_load_dwordx4 v7, s[52:55], s77 offen offset:2048 lds
    s_add_u32 s77, s77, 110592
    s_cmp_eq_u32 s77, 2211840
    s_cselect_b32 s77, 0, s77
    s_waitcnt vmcnt(30)
    s_barrier
    s_mov_b32 m0, 74752
    s_nop 0
    buffer_load_dwordx4 v64, s[44:47], s78 offen offset:0 lds
    buffer_load_dwordx4 v65, s[44:47], s78 offen offset:1024 lds
    buffer_load_dwordx4 v66, s[44:47], s78 offen offset:2048 lds
    buffer_load_dwordx4 v67, s[44:47], s78 offen offset:3072 lds
    s_mov_b32 m0, 78848
    s_nop 0
    buffer_load_dwordx4 v68, s[44:47], s78 offen offset:0 lds
    buffer_load_dwordx4 v69, s[44:47], s78 offen offset:1024 lds
    buffer_load_dwordx4 v70, s[44:47], s78 offen offset:2048 lds
    buffer_load_dwordx4 v71, s[44:47], s78 offen offset:3072 lds
    s_mov_b32 m0, 82944
    s_nop 0
    buffer_load_dwordx4 v72, s[44:47], s78 offen offset:0 lds
    buffer_load_dwordx4 v73, s[44:47], s78 offen offset:1024 lds
    buffer_load_dwordx4 v74, s[44:47], s78 offen offset:2048 lds
    buffer_load_dwordx4 v75, s[44:47], s78 offen offset:3072 lds
    s_mov_b32 m0, 87040
    s_nop 0
    buffer_load_dwordx4 v76, s[44:47], s78 offen offset:0 lds
    buffer_load_dwordx4 v77, s[44:47], s78 offen offset:1024 lds
    buffer_load_dwordx4 v78, s[44:47], s78 offen offset:2048 lds
    buffer_load_dwordx4 v79, s[44:47], s78 offen offset:3072 lds
    s_mov_b32 m0, 43776
    s_nop 0
    buffer_load_dwordx4 v1, s[48:51], s77 offen offset:0 lds
    buffer_load_dwordx4 v2, s[48:51], s77 offen offset:1024 lds
    buffer_load_dwordx4 v3, s[48:51], s77 offen offset:2048 lds
    buffer_load_dwordx4 v4, s[48:51], s77 offen offset:3072 lds
    s_mov_b32 m0, 47872
    s_nop 0
    buffer_load_dwordx4 v5, s[48:51], s77 offen offset:0 lds
    buffer_load_dwordx4 v6, s[48:51], s77 offen offset:1024 lds
    s_waitcnt vmcnt(44)
    v_xor_b32 v148, s66, v148
    v_xor_b32 v149, s66, v149
    v_xor_b32 v150, s66, v150
    v_xor_b32 v151, s66, v151
    v_xor_b32 v154, s66, v154
    v_xor_b32 v155, s66, v155
    v_or3_b32 v148, v148, v149, v150
    v_or3_b32 v148, v148, v151, v155
    v_or_b32 v148, v148, v154
    v_cmp_ne_u32 vcc, 0, v148
    s_cbranch_vccz L_aok_11
    s_mov_b32 s76, 262144
L_polla_12:
    buffer_load_dwordx4 v[148:151], v59, s[40:43], s70 offen sc0 sc1
    buffer_load_dwordx2 v[154:155], v60, s[40:43], s72 offen sc0 sc1
    s_waitcnt vmcnt(0)
    v_xor_b32 v148, s66, v148
    v_xor_b32 v149, s66, v149
    v_xor_b32 v150, s66, v150
    v_xor_b32 v151, s66, v151
    v_xor_b32 v154, s66, v154
    v_xor_b32 v155, s66, v155
    v_or3_b32 v148, v148, v149, v150
    v_or3_b32 v148, v148, v151, v155
    v_or_b32 v148, v148, v154
    v_cmp_ne_u32 vcc, 0, v148
    s_cbranch_vccz L_polla_ok_13
    s_sub_u32 s76, s76, 1
    s_cmp_lg_u32 s76, 0
    s_cbranch_scc1 L_polla_12
L_polla_ok_13:
L_aok_11:
    s_waitcnt vmcnt(36)
    s_barrier
    buffer_load_dwordx4 v7, s[48:51], s77 offen offset:2048 lds
    s_mov_b32 m0, 51072
    s_nop 0
    buffer_load_dwordx4 v1, s[52:55], s77 offen offset:0 lds
    buffer_load_dwordx4 v2, s[52:55], s77 offen offset:1024 lds
    buffer_load_dwordx4 v3, s[52:55], s77 offen offset:2048 lds
    buffer_load_dwordx4 v4, s[52:55], s77 offen offset:3072 lds
    s_mov_b32 m0, 55168
    s_nop 0
    buffer_load_dwordx4 v5, s[52:55], s77 offen offset:0 lds
    buffer_load_dwordx4 v6, s[52:55], s77 offen offset:1024 lds
    buffer_load_dwordx4 v7, s[52:55], s77 offen offset:2048 lds
    s_add_u32 s71, s62, s63
    s_and_b32 s71, s71, 3
    s_lshl_b32 s74, s65, 4
    s_add_u32 s74, s74, 90112
    s_mov_b32 exec_lo, 0x77777777
    s_mov_b32 exec_hi, 0x77777777
    s_add_u32 s70, s71, 0
    s_and_b32 s70, s70, 3
    s_mul_i32 s70, s70, 655360
    s_add_u32 s70, s70, s74
    buffer_load_dwordx4 v[80:83], v57, s[40:43], s70 offen sc1
    s_add_u32 s70, s70, 163840
    buffer_load_dwordx4 v[84:87], v57, s[40:43], s70 offen sc1
    s_add_u32 s70, s70, 163840
    buffer_load_dwordx4 v[88:91], v57, s[40:43], s70 offen sc1
    s_add_u32 s70, s70, 163840
    buffer_load_dwordx4 v[92:95], v57, s[40:43], s70 offen sc1
    s_add_u32 s70, s71, 1
    s_and_b32 s70, s70, 3
    s_mul_i32 s70, s70, 655360
    s_add_u32 s70, s70, s74
    buffer_load_dwordx4 v[96:99], v57, s[40:43], s70 offen sc1
    s_add_u32 s70, s70, 163840
    s_mov_b64 exec, -1
    s_cmp_lg_u32 s2, 0
    s_cbranch_scc1 L_noep_14
    s_mov_b32 s73, 0
    v_mov_b32 v152, s66
    v_mov_b32 v153, 0
    s_mov_b64 exec, 1
    buffer_store_dword v152, v153, s[40:43], s73 offen sc0 sc1
    s_mov_b64 exec, -1
L_noep_14:
    s_waitcnt vmcnt(19)
    s_barrier
    s_mov_b32 exec_lo, 0x77777777
    s_mov_b32 exec_hi, 0x77777777
    buffer_load_dwordx4 v[100:103], v57, s[40:43], s70 offen sc1
    s_add_u32 s70, s70, 163840
    buffer_load_dwordx4 v[104:107], v57, s[40:43], s70 offen sc1
    s_add_u32 s70, s70, 163840
    buffer_load_dwordx4 v[108:111], v57, s[40:43], s70 offen sc1
    s_add_u32 s70, s71, 2
    s_and_b32 s70, s70, 3
    s_mul_i32 s70, s70, 655360
    s_add_u32 s70, s70, s74
    buffer_load_dwordx4 v[112:115], v57, s[40:43], s70 offen sc1
    s_add_u32 s70, s70, 163840
    buffer_load_dwordx4 v[116:119], v57, s[40:43], s70 offen sc1
    s_add_u32 s70, s70, 163840
    s_mov_b64 exec, -1
    s_waitcnt vmcnt(10)
    s_barrier
    s_mov_b32 exec_lo, 0x77777777
    s_mov_b32 exec_hi, 0x77777777
    buffer_load_dwordx4 v[120:123], v57, s[40:43], s70 offen sc1
    s_add_u32 s70, s70, 163840
    buffer_load_dwordx4 v[124:127], v57, s[40:43], s70 offen sc1
    s_add_u32 s70, s71, 3
    s_and_b32 s70, s70, 3
    s_mul_i32 s70, s70, 655360
    s_add_u32 s70, s70, s74
    buffer_load_dwordx4 v[128:131], v57, s[40:43], s70 offen sc1
    s_add_u32 s70, s70, 163840
    buffer_load_dwordx4 v[132:135], v57, s[40:43], s70 offen sc1
    s_add_u32 s70, s70, 163840
    buffer_load_dwordx4 v[136:139], v57, s[40:43], s70 offen sc1
    s_add_u32 s70, s70, 163840
    buffer_load_dwordx4 v[140:143], v57, s[40:43], s70 offen sc1
    s_mov_b64 exec, -1
    s_barrier
    s_mov_b32 exec_lo, 0x77777777
    s_mov_b32 exec_hi, 0x77777777
    s_add_u32 s70, s71, 0
    s_and_b32 s70, s70, 3
    s_lshl_b32 s70, s70, 10
    v_add_u32 v60, s70, v58
    s_waitcnt vmcnt(12)
    ds_write_b128 v60, v[80:83] offset:0
    ds_write_b128 v60, v[84:87] offset:256
    ds_write_b128 v60, v[88:91] offset:512
    ds_write_b128 v60, v[92:95] offset:768
    s_add_u32 s70, s71, 1
    s_and_b32 s70, s70, 3
    s_lshl_b32 s70, s70, 10
    v_add_u32 v60, s70, v58
    s_waitcnt vmcnt(8)
    ds_write_b128 v60, v[96:99] offset:0
    ds_write_b128 v60, v[100:103] offset:256
    ds_write_b128 v60, v[104:107] offset:512
    ds_write_b128 v60, v[108:111] offset:768
    s_add_u32 s70, s71, 2
    s_and_b32 s70, s70, 3
    s_lshl_b32 s70, s70, 10
    v_add_u32 v60, s70, v58
    s_waitcnt vmcnt(4)
    ds_write_b128 v60, v[112:115] offset:0
    ds_write_b128 v60, v[116:119] offset:256
    ds_write_b128 v60, v[120:123] offset:512
    ds_write_b128 v60, v[124:127] offset:768
    s_add_u32 s70, s71, 3
    s_and_b32 s70, s70, 3
    s_lshl_b32 s70, s70, 10
    v_add_u32 v60, s70, v58
    s_waitcnt vmcnt(0)
    ds_write_b128 v60, v[128:131] offset:0
    ds_write_b128 v60, v[132:135] offset:256
    ds_write_b128 v60, v[136:139] offset:512
    ds_write_b128 v60, v[140:143] offset:768
    s_mov_b64 exec, -1
    v_mov_b32 v152, 162752
    v_mov_b32 v153, 1
    s_waitcnt lgkmcnt(0)
    ds_write_b32 v152, v153
    s_waitcnt vmcnt(0) lgkmcnt(0)
    s_endpgm
L_g_b0:
    s_waitcnt lgkmcnt(0)
    s_barrier
    ds_read_b128 v[32:35], v5 offset:0
    ds_read_b64_tr_b16 v[16:17], v1 offset:0
    ds_read_b64_tr_b16 v[18:19], v1 offset:896
    ds_read_b128 v[36:39], v6 offset:0
    ds_read_b64_tr_b16 v[20:21], v1 offset:32
    ds_read_b64_tr_b16 v[22:23], v1 offset:928
    ds_read_b64_tr_b16 v[24:25], v1 offset:64
    ds_read_b64_tr_b16 v[26:27], v1 offset:960
    ds_read_b64_tr_b16 v[28:29], v3 offset:0
    ds_read_b64_tr_b16 v[30:31], v3 offset:896
    s_mov_b32 s74, 4
.p2align 6
L_g1:
    s_waitcnt lgkmcnt(7)
    v_mfma_f32_32x32x16_bf16 v[64:79], v[16:19], v[32:35], v[64:79]
    ds_read_b128 v[56:59], v7 offset:0
    ds_read_b64_tr_b16 v[40:41], v2 offset:0
    s_waitcnt lgkmcnt(8)
    v_mfma_f32_32x32x16_bf16 v[80:95], v[16:19], v[36:39], v[80:95]
    ds_read_b64_tr_b16 v[42:43], v2 offset:896
    ds_read_b128 v[60:63], v8 offset:0
    s_waitcnt lgkmcnt(8)
    v_mfma_f32_32x32x16_bf16 v[96:111], v[20:23], v[32:35], v[96:111]
    ds_read_b64_tr_b16 v[44:45], v2 offset:32
    ds_read_b64_tr_b16 v[46:47], v2 offset:928
    v_mfma_f32_32x32x16_bf16 v[112:127], v[20:23], v[36:39], v[112:127]
    ds_read_b64_tr_b16 v[48:49], v2 offset:64
    ds_read_b64_tr_b16 v[50:51], v2 offset:960
    s_waitcnt lgkmcnt(10)
    v_mfma_f32_32x32x16_bf16 v[128:143], v[24:27], v[32:35], v[128:143]
    ds_read_b64_tr_b16 v[52:53], v4 offset:0
    ds_read_b64_tr_b16 v[54:55], v4 offset:896
    v_mfma_f32_32x32x16_bf16 v[144:159], v[24:27], v[36:39], v[144:159]
    s_waitcnt lgkmcnt(10)
    v_mfma_f32_32x32x16_bf16 v[160:175], v[28:31], v[32:35], v[160:175]
    s_waitcnt lgkmcnt(0)
    v_mfma_f32_32x32x16_bf16 v[64:79], v[40:43], v[56:59], v[64:79]
    s_waitcnt lgkmcnt(0)
    s_barrier
    v_mfma_f32_32x32x16_bf16 v[80:95], v[40:43], v[60:63], v[80:95]
    ds_read_b128 v[32:35], v10 offset:0
    ds_read_b64_tr_b16 v[16:17], v1 offset:14592
    v_mfma_f32_32x32x16_bf16 v[96:111], v[44:47], v[56:59], v[96:111]
    ds_read_b64_tr_b16 v[18:19], v1 offset:15488
    ds_read_b128 v[36:39], v11 offset:0
    v_mfma_f32_32x32x16_bf16 v[112:127], v[44:47], v[60:63], v[112:127]
    ds_read_b64_tr_b16 v[20:21], v1 offset:14624
    ds_read_b64_tr_b16 v[22:23], v1 offset:15520
    v_mfma_f32_32x32x16_bf16 v[128:143], v[48:51], v[56:59], v[128:143]
    ds_read_b64_tr_b16 v[24:25], v1 offset:14656
    ds_read_b64_tr_b16 v[26:27], v1 offset:15552
    v_mfma_f32_32x32x16_bf16 v[144:159], v[48:51], v[60:63], v[144:159]
    ds_read_b64_tr_b16 v[28:29], v3 offset:14592
    ds_read_b64_tr_b16 v[30:31], v3 offset:15488
    v_mfma_f32_32x32x16_bf16 v[160:175], v[52:55], v[56:59], v[160:175]
    s_waitcnt lgkmcnt(7)
    v_mfma_f32_32x32x16_bf16 v[64:79], v[16:19], v[32:35], v[64:79]
    ds_read_b128 v[56:59], v12 offset:0
    ds_read_b64_tr_b16 v[40:41], v2 offset:14592
    s_waitcnt lgkmcnt(8)
    v_mfma_f32_32x32x16_bf16 v[80:95], v[16:19], v[36:39], v[80:95]
    ds_read_b64_tr_b16 v[42:43], v2 offset:15488
    ds_read_b128 v[60:63], v13 offset:0
    s_waitcnt lgkmcnt(8)
    v_mfma_f32_32x32x16_bf16 v[96:111], v[20:23], v[32:35], v[96:111]
    ds_read_b64_tr_b16 v[44:45], v2 offset:14624
    ds_read_b64_tr_b16 v[46:47], v2 offset:15520
    v_mfma_f32_32x32x16_bf16 v[112:127], v[20:23], v[36:39], v[112:127]
    ds_read_b64_tr_b16 v[48:49], v2 offset:14656
    ds_read_b64_tr_b16 v[50:51], v2 offset:15552
    s_waitcnt lgkmcnt(10)
    v_mfma_f32_32x32x16_bf16 v[128:143], v[24:27], v[32:35], v[128:143]
    ds_read_b64_tr_b16 v[52:53], v4 offset:14592
    ds_read_b64_tr_b16 v[54:55], v4 offset:15488
    v_mfma_f32_32x32x16_bf16 v[144:159], v[24:27], v[36:39], v[144:159]
    s_waitcnt lgkmcnt(10)
    v_mfma_f32_32x32x16_bf16 v[160:175], v[28:31], v[32:35], v[160:175]
    s_waitcnt lgkmcnt(0)
    v_mfma_f32_32x32x16_bf16 v[64:79], v[40:43], v[56:59], v[64:79]
    s_waitcnt lgkmcnt(0)
    s_barrier
    v_mfma_f32_32x32x16_bf16 v[80:95], v[40:43], v[60:63], v[80:95]
    ds_read_b128 v[32:35], v5 offset:16384
    ds_read_b64_tr_b16 v[16:17], v1 offset:29184
    v_mfma_f32_32x32x16_bf16 v[96:111], v[44:47], v[56:59], v[96:111]
    ds_read_b64_tr_b16 v[18:19], v1 offset:30080
    ds_read_b128 v[36:39], v6 offset:16384
    v_mfma_f32_32x32x16_bf16 v[112:127], v[44:47], v[60:63], v[112:127]
    ds_read_b64_tr_b16 v[20:21], v1 offset:29216
    ds_read_b64_tr_b16 v[22:23], v1 offset:30112
    v_mfma_f32_32x32x16_bf16 v[128:143], v[48:51], v[56:59], v[128:143]
    ds_read_b64_tr_b16 v[24:25], v1 offset:29248
    ds_read_b64_tr_b16 v[26:27], v1 offset:30144
    v_mfma_f32_32x32x16_bf16 v[144:159], v[48:51], v[60:63], v[144:159]
    ds_read_b64_tr_b16 v[28:29], v3 offset:29184
    ds_read_b64_tr_b16 v[30:31], v3 offset:30080
    v_mfma_f32_32x32x16_bf16 v[160:175], v[52:55], v[56:59], v[160:175]
    s_waitcnt lgkmcnt(7)
    v_mfma_f32_32x32x16_bf16 v[64:79], v[16:19], v[32:35], v[64:79]
    ds_read_b128 v[56:59], v7 offset:16384
    ds_read_b64_tr_b16 v[40:41], v2 offset:29184
    s_waitcnt lgkmcnt(8)
    v_mfma_f32_32x32x16_bf16 v[80:95], v[16:19], v[36:39], v[80:95]
    ds_read_b64_tr_b16 v[42:43], v2 offset:30080
    ds_read_b128 v[60:63], v8 offset:16384
    s_waitcnt lgkmcnt(8)
    v_mfma_f32_32x32x16_bf16 v[96:111], v[20:23], v[32:35], v[96:111]
    ds_read_b64_tr_b16 v[44:45], v2 offset:29216
    ds_read_b64_tr_b16 v[46:47], v2 offset:30112
    v_mfma_f32_32x32x16_bf16 v[112:127], v[20:23], v[36:39], v[112:127]
    ds_read_b64_tr_b16 v[48:49], v2 offset:29248
    ds_read_b64_tr_b16 v[50:51], v2 offset:30144
    s_waitcnt lgkmcnt(10)
    v_mfma_f32_32x32x16_bf16 v[128:143], v[24:27], v[32:35], v[128:143]
    ds_read_b64_tr_b16 v[52:53], v4 offset:29184
    ds_read_b64_tr_b16 v[54:55], v4 offset:30080
    v_mfma_f32_32x32x16_bf16 v[144:159], v[24:27], v[36:39], v[144:159]
    s_waitcnt lgkmcnt(10)
    v_mfma_f32_32x32x16_bf16 v[160:175], v[28:31], v[32:35], v[160:175]
    s_waitcnt lgkmcnt(0)
    v_mfma_f32_32x32x16_bf16 v[64:79], v[40:43], v[56:59], v[64:79]
    s_waitcnt lgkmcnt(0)
    s_barrier
    v_mfma_f32_32x32x16_bf16 v[80:95], v[40:43], v[60:63], v[80:95]
    ds_read_b128 v[32:35], v10 offset:16384
    ds_read_b64_tr_b16 v[16:17], v1 offset:43776
    v_mfma_f32_32x32x16_bf16 v[96:111], v[44:47], v[56:59], v[96:111]
    ds_read_b64_tr_b16 v[18:19], v1 offset:44672
    ds_read_b128 v[36:39], v11 offset:16384
    v_mfma_f32_32x32x16_bf16 v[112:127], v[44:47], v[60:63], v[112:127]
    ds_read_b64_tr_b16 v[20:21], v1 offset:43808
    ds_read_b64_tr_b16 v[22:23], v1 offset:44704
    v_mfma_f32_32x32x16_bf16 v[128:143], v[48:51], v[56:59], v[128:143]
    ds_read_b64_tr_b16 v[24:25], v1 offset:43840
    ds_read_b64_tr_b16 v[26:27], v1 offset:44736
    v_mfma_f32_32x32x16_bf16 v[144:159], v[48:51], v[60:63], v[144:159]
    ds_read_b64_tr_b16 v[28:29], v3 offset:43776
    ds_read_b64_tr_b16 v[30:31], v3 offset:44672
    v_mfma_f32_32x32x16_bf16 v[160:175], v[52:55], v[56:59], v[160:175]
    s_waitcnt lgkmcnt(7)
    v_mfma_f32_32x32x16_bf16 v[64:79], v[16:19], v[32:35], v[64:79]
    ds_read_b128 v[56:59], v12 offset:16384
    ds_read_b64_tr_b16 v[40:41], v2 offset:43776
    s_waitcnt lgkmcnt(8)
    v_mfma_f32_32x32x16_bf16 v[80:95], v[16:19], v[36:39], v[80:95]
    ds_read_b64_tr_b16 v[42:43], v2 offset:44672
    ds_read_b128 v[60:63], v13 offset:16384
    s_waitcnt lgkmcnt(8)
    v_mfma_f32_32x32x16_bf16 v[96:111], v[20:23], v[32:35], v[96:111]
    ds_read_b64_tr_b16 v[44:45], v2 offset:43808
    ds_read_b64_tr_b16 v[46:47], v2 offset:44704
    v_mfma_f32_32x32x16_bf16 v[112:127], v[20:23], v[36:39], v[112:127]
    ds_read_b64_tr_b16 v[48:49], v2 offset:43840
    ds_read_b64_tr_b16 v[50:51], v2 offset:44736
    s_waitcnt lgkmcnt(10)
    v_mfma_f32_32x32x16_bf16 v[128:143], v[24:27], v[32:35], v[128:143]
    ds_read_b64_tr_b16 v[52:53], v4 offset:43776
    ds_read_b64_tr_b16 v[54:55], v4 offset:44672
    v_mfma_f32_32x32x16_bf16 v[144:159], v[24:27], v[36:39], v[144:159]
    s_waitcnt lgkmcnt(10)
    v_mfma_f32_32x32x16_bf16 v[160:175], v[28:31], v[32:35], v[160:175]
    s_waitcnt lgkmcnt(0)
    v_mfma_f32_32x32x16_bf16 v[64:79], v[40:43], v[56:59], v[64:79]
    s_waitcnt lgkmcnt(0)
    s_barrier
    v_mfma_f32_32x32x16_bf16 v[80:95], v[40:43], v[60:63], v[80:95]
    ds_read_b128 v[32:35], v5 offset:0
    ds_read_b64_tr_b16 v[16:17], v1 offset:0
    v_mfma_f32_32x32x16_bf16 v[96:111], v[44:47], v[56:59], v[96:111]
    ds_read_b64_tr_b16 v[18:19], v1 offset:896
    ds_read_b128 v[36:39], v6 offset:0
    v_mfma_f32_32x32x16_bf16 v[112:127], v[44:47], v[60:63], v[112:127]
    ds_read_b64_tr_b16 v[20:21], v1 offset:32
    ds_read_b64_tr_b16 v[22:23], v1 offset:928
    v_mfma_f32_32x32x16_bf16 v[128:143], v[48:51], v[56:59], v[128:143]
    ds_read_b64_tr_b16 v[24:25], v1 offset:64
    ds_read_b64_tr_b16 v[26:27], v1 offset:960
    v_mfma_f32_32x32x16_bf16 v[144:159], v[48:51], v[60:63], v[144:159]
    ds_read_b64_tr_b16 v[28:29], v3 offset:0
    ds_read_b64_tr_b16 v[30:31], v3 offset:896
    v_mfma_f32_32x32x16_bf16 v[160:175], v[52:55], v[56:59], v[160:175]
    s_sub_u32 s74, s74, 1
    s_cmp_lg_u32 s74, 0
    s_cbranch_scc1 L_g1
    s_waitcnt lgkmcnt(7)
    v_mfma_f32_32x32x16_bf16 v[64:79], v[16:19], v[32:35], v[64:79]
    ds_read_b128 v[56:59], v7 offset:0
    ds_read_b64_tr_b16 v[40:41], v2 offset:0
    s_lshl_b32 s69, s58, 7
    s_lshl_b32 s70, s3, 6
    s_add_u32 s69, s69, s70
    s_lshl_b32 s70, s4, 5
    s_add_u32 s71, s69, s70
    s_waitcnt lgkmcnt(8)
    v_mfma_f32_32x32x16_bf16 v[80:95], v[16:19], v[36:39], v[80:95]
    ds_read_b64_tr_b16 v[42:43], v2 offset:896
    ds_read_b128 v[60:63], v8 offset:0
    s_sub_u32 s72, s69, s70
    s_add_u32 s72, s72, 32
    s_lshl_b32 s71, s71, 3
    s_lshl_b32 s72, s72, 3
    s_add_u32 s71, s71, 16384
    s_waitcnt lgkmcnt(8)
    v_mfma_f32_32x32x16_bf16 v[96:111], v[20:23], v[32:35], v[96:111]
    ds_read_b64_tr_b16 v[44:45], v2 offset:32
    ds_read_b64_tr_b16 v[46:47], v2 offset:928
    s_add_u32 s72, s72, 16384
    v_and_b32 v183, 31, v0
    v_lshlrev_b32 v183, 3, v183
    v_lshrrev_b32 v184, 5, v0
    v_mul_u32_u24 v184, 3456, v184
    v_mfma_f32_32x32x16_bf16 v[112:127], v[20:23], v[36:39], v[112:127]
    ds_read_b64_tr_b16 v[48:49], v2 offset:64
    ds_read_b64_tr_b16 v[50:51], v2 offset:960
    v_bfe_u32 v185, v0, 4, 1
    v_mul_u32_u24 v185, 1728, v185
    v_and_b32 v182, 15, v0
    v_add3_u32 v184, v184, v185, v182
    v_lshlrev_b32 v184, 2, v184
    s_waitcnt lgkmcnt(10)
    v_mfma_f32_32x32x16_bf16 v[128:143], v[24:27], v[32:35], v[128:143]
    ds_read_b64_tr_b16 v[52:53], v4 offset:0
    ds_read_b64_tr_b16 v[54:55], v4 offset:896
    s_mul_i32 s69, s4, 3
    s_add_u32 s69, s69, s61
    s_lshl_b32 s69, s69, 6
    s_add_u32 s69, s69, 32768
    s_lshl_b32 s70, s61, 6
    v_mfma_f32_32x32x16_bf16 v[144:159], v[24:27], v[36:39], v[144:159]
    s_add_u32 s70, s70, 33152
    s_waitcnt lgkmcnt(10)
    v_mfma_f32_32x32x16_bf16 v[160:175], v[28:31], v[32:35], v[160:175]
    s_mul_i32 s73, s60, 160
    s_mov_b32 s74, 6554
    v_add_u32 v222, 0, v0
    v_mul_u32_u24 v223, s74, v222
    v_lshrrev_b32 v223, 16, v223
    s_waitcnt lgkmcnt(0)
    v_mfma_f32_32x32x16_bf16 v[64:79], v[40:43], v[56:59], v[64:79]
    s_waitcnt lgkmcnt(0)
    s_barrier
    v_mfma_f32_32x32x16_bf16 v[80:95], v[40:43], v[60:63], v[80:95]
    ds_read_b128 v[32:35], v10 offset:0
    ds_read_b64_tr_b16 v[16:17], v1 offset:14592
    buffer_load_dword v208, v183, s[40:43], s71 offen sc1
    buffer_load_dword v212, v183, s[40:43], s72 offen sc1
    v_mfma_f32_32x32x16_bf16 v[96:111], v[44:47], v[56:59], v[96:111]
    ds_read_b64_tr_b16 v[18:19], v1 offset:15488
    ds_read_b128 v[36:39], v11 offset:0
    buffer_load_dword v176, v184, s[40:43], s69 offen offset:0 sc1
    buffer_load_dword v177, v184, s[40:43], s69 offen offset:64 sc1
    v_mfma_f32_32x32x16_bf16 v[112:127], v[44:47], v[60:63], v[112:127]
    ds_read_b64_tr_b16 v[20:21], v1 offset:14624
    ds_read_b64_tr_b16 v[22:23], v1 offset:15520
    buffer_load_dword v178, v184, s[40:43], s69 offen offset:128 sc1
    buffer_load_dword v179, v184, s[40:43], s70 offen offset:0 sc1
    v_mfma_f32_32x32x16_bf16 v[128:143], v[48:51], v[56:59], v[128:143]
    ds_read_b64_tr_b16 v[24:25], v1 offset:14656
    ds_read_b64_tr_b16 v[26:27], v1 offset:15552
    v_mul_u32_u24 v224, 10, v223
    v_sub_u32 v224, v222, v224
    v_mul_u32_u24 v223, 1280, v223
    v_lshl_add_u32 v223, v224, 4, v223
    v_add_u32 v216, s73, v223
    v_mfma_f32_32x32x16_bf16 v[144:159], v[48:51], v[60:63], v[144:159]
    ds_read_b64_tr_b16 v[28:29], v3 offset:14592
    ds_read_b64_tr_b16 v[30:31], v3 offset:15488
    v_add_u32 v222, 64, v0
    v_mul_u32_u24 v223, s74, v222
    v_lshrrev_b32 v223, 16, v223
    v_mul_u32_u24 v224, 10, v223
    v_sub_u32 v224, v222, v224
    v_mfma_f32_32x32x16_bf16 v[160:175], v[52:55], v[56:59], v[160:175]
    v_mul_u32_u24 v223, 1280, v223
    v_lshl_add_u32 v223, v224, 4, v223
    v_add_u32 v217, s73, v223
    v_subrev_u32 v217, 1024, v217
    v_add_u32 v222, 128, v0
    s_waitcnt lgkmcnt(7)
    v_mfma_f32_32x32x16_bf16 v[64:79], v[16:19], v[32:35], v[64:79]
    ds_read_b128 v[56:59], v12 offset:0
    ds_read_b64_tr_b16 v[40:41], v2 offset:14592
    v_mul_u32_u24 v223, s74, v222
    v_lshrrev_b32 v223, 16, v223
    v_mul_u32_u24 v224, 10, v223
    v_sub_u32 v224, v222, v224
    v_mul_u32_u24 v223, 1280, v223
    v_lshl_add_u32 v223, v224, 4, v223
    v_add_u32 v218, s73, v223
    v_subrev_u32 v218, 2048, v218
    v_add_u32 v222, 192, v0
    v_mul_u32_u24 v223, s74, v222
    s_waitcnt lgkmcnt(8)
    v_mfma_f32_32x32x16_bf16 v[80:95], v[16:19], v[36:39], v[80:95]
    ds_read_b64_tr_b16 v[42:43], v2 offset:15488
    ds_read_b128 v[60:63], v13 offset:0
    v_lshrrev_b32 v223, 16, v223
    v_mul_u32_u24 v224, 10, v223
    v_sub_u32 v224, v222, v224
    v_mul_u32_u24 v223, 1280, v223
    v_lshl_add_u32 v223, v224, 4, v223
    v_add_u32 v219, s73, v223
    v_subrev_u32 v219, 3072, v219
    v_add_u32 v222, 256, v0
    v_mul_u32_u24 v223, s74, v222
    v_lshrrev_b32 v223, 16, v223
    s_waitcnt lgkmcnt(8)
    v_mfma_f32_32x32x16_bf16 v[96:111], v[20:23], v[32:35], v[96:111]
    ds_read_b64_tr_b16 v[44:45], v2 offset:14624
    ds_read_b64_tr_b16 v[46:47], v2 offset:15520
    v_mul_u32_u24 v224, 10, v223
    v_sub_u32 v224, v222, v224
    v_mul_u32_u24 v223, 1280, v223
    v_lshl_add_u32 v223, v224, 4, v223
    v_add_u32 v220, s73, v223
    s_mul_i32 s5, s57, 5120
    s_mul_i32 s99, s57, 552960
    s_add_u32 s100, s99, 573440
    s_and_b32 s73, s59, 3
    s_mul_i32 s73, s73, 7
    v_mfma_f32_32x32x16_bf16 v[112:127], v[20:23], v[36:39], v[112:127]
    ds_read_b64_tr_b16 v[48:49], v2 offset:14656
    ds_read_b64_tr_b16 v[50:51], v2 offset:15552
    s_add_u32 s73, s73, 1
    s_lshr_b32 s73, s73, 1
    s_mul_i32 s74, s60, 0
    s_add_u32 s74, s74, 2
    s_lshr_b32 s74, s74, 2
    s_add_u32 s75, s73, s74
    s_and_b32 s74, s2, 7
    s_mul_i32 s74, s74, 0
    s_lshr_b32 s74, s74, 2
    s_add_u32 s75, s75, s74
    s_waitcnt lgkmcnt(10)
    v_mfma_f32_32x32x16_bf16 v[128:143], v[24:27], v[32:35], v[128:143]
    ds_read_b64_tr_b16 v[52:53], v4 offset:14592
    ds_read_b64_tr_b16 v[54:55], v4 offset:15488
    s_cmp_ge_u32 s75, 14
    s_cselect_b32 s73, 14, 0
    s_sub_u32 s75, s75, s73
    s_mul_i32 s6, s75, 40960
    s_add_u32 s6, s6, s99
    v_lshrrev_b32 v222, 5, v0
    v_lshlrev_b32 v222, 4, v222
    v_bfe_u32 v223, v0, 4, 1
    v_lshl_add_u32 v222, v223, 2, v222
    v_bfe_u32 v223, v0, 2, 2
    v_mfma_f32_32x32x16_bf16 v[144:159], v[24:27], v[36:39], v[144:159]
    v_add_u32 v222, v222, v223
    v_mul_u32_u24 v222, 160, v222
    v_and_b32 v223, 3, v0
    v_lshl_add_u32 v222, v223, 3, v222
    v_add_u32 v221, s5, v222
    s_waitcnt lgkmcnt(10)
    v_mfma_f32_32x32x16_bf16 v[160:175], v[28:31], v[32:35], v[160:175]
    s_waitcnt lgkmcnt(0)
    v_mfma_f32_32x32x16_bf16 v[64:79], v[40:43], v[56:59], v[64:79]
    s_waitcnt lgkmcnt(0)
    s_barrier
    v_mfma_f32_32x32x16_bf16 v[80:95], v[40:43], v[60:63], v[80:95]
    ds_read_b128 v[32:35], v5 offset:16384
    ds_read_b64_tr_b16 v[16:17], v1 offset:29184
    s_add_u32 m0, s5, 0
    s_nop 0
    buffer_load_dwordx4 v216, s[48:51], s6 offen offset:0 lds
    buffer_load_dwordx4 v217, s[48:51], s6 offen offset:1024 lds
    v_mfma_f32_32x32x16_bf16 v[96:111], v[44:47], v[56:59], v[96:111]
    ds_read_b64_tr_b16 v[18:19], v1 offset:30080
    ds_read_b128 v[36:39], v6 offset:16384
    buffer_load_dwordx4 v218, s[48:51], s6 offen offset:2048 lds
    buffer_load_dwordx4 v219, s[48:51], s6 offen offset:3072 lds
    v_mfma_f32_32x32x16_bf16 v[112:127], v[44:47], v[60:63], v[112:127]
    ds_read_b64_tr_b16 v[20:21], v1 offset:29216
    ds_read_b64_tr_b16 v[22:23], v1 offset:30112
    s_add_u32 m0, s5, 4096
    s_nop 0
    buffer_load_dwordx4 v220, s[48:51], s6 offen offset:0 lds
    s_add_u32 s6, s6, 40960
    s_cmp_eq_u32 s6, s100
    s_cselect_b32 s6, s99, s6
    v_mfma_f32_32x32x16_bf16 v[128:143], v[48:51], v[56:59], v[128:143]
    ds_read_b64_tr_b16 v[24:25], v1 offset:29248
    ds_read_b64_tr_b16 v[26:27], v1 offset:30144
    v_mfma_f32_32x32x16_bf16 v[144:159], v[48:51], v[60:63], v[144:159]
    ds_read_b64_tr_b16 v[28:29], v3 offset:29184
    ds_read_b64_tr_b16 v[30:31], v3 offset:30080
    v_mfma_f32_32x32x16_bf16 v[160:175], v[52:55], v[56:59], v[160:175]
    s_waitcnt lgkmcnt(7)
    v_mfma_f32_32x32x16_bf16 v[64:79], v[16:19], v[32:35], v[64:79]
    ds_read_b128 v[56:59], v7 offset:16384
    ds_read_b64_tr_b16 v[40:41], v2 offset:29184
    s_lshl_b32 s72, s58, 3
    s_lshl_b32 s73, s3, 2
    s_add_u32 s72, s72, s73
    s_mul_i32 s72, s72, 57344
    s_mul_i32 s73, s63, 14336
    s_waitcnt lgkmcnt(8)
    v_mfma_f32_32x32x16_bf16 v[80:95], v[16:19], v[36:39], v[80:95]
    ds_read_b64_tr_b16 v[42:43], v2 offset:30080
    ds_read_b128 v[60:63], v8 offset:16384
    s_add_u32 s72, s72, s73
    s_mul_i32 s73, s62, 3584
    s_add_u32 s72, s72, s73
    s_add_u32 s72, s72, 5332992
    s_mul_i32 s73, s4, 114688
    s_waitcnt lgkmcnt(8)
    v_mfma_f32_32x32x16_bf16 v[96:111], v[20:23], v[32:35], v[96:111]
    ds_read_b64_tr_b16 v[44:45], v2 offset:29216
    ds_read_b64_tr_b16 v[46:47], v2 offset:30112
    s_add_u32 s78, s72, s73
    s_sub_u32 s77, s72, s73
    s_add_u32 s77, s77, 114688
    s_mul_i32 s73, s4, 1536
    s_add_u32 s7, s78, s73
    v_mfma_f32_32x32x16_bf16 v[112:127], v[20:23], v[36:39], v[112:127]
    ds_read_b64_tr_b16 v[48:49], v2 offset:29248
    ds_read_b64_tr_b16 v[50:51], v2 offset:30144
    s_add_u32 s77, s77, s73
    s_add_u32 s78, s78, 3072
    s_cmp_eq_u32 s62, 3
    s_cselect_b32 s101, 0, -1
    s_lshl_b32 s72, s58, 1
    s_waitcnt lgkmcnt(10)
    v_mfma_f32_32x32x16_bf16 v[128:143], v[24:27], v[32:35], v[128:143]
    ds_read_b64_tr_b16 v[52:53], v4 offset:29184
    ds_read_b64_tr_b16 v[54:55], v4 offset:30080
    s_add_u32 s72, s72, s3
    s_lshl_b32 s72, s72, 4
    s_lshl_b32 s73, s63, 2
    s_add_u32 s72, s72, s73
    s_add_u32 s72, s72, s62
    v_mfma_f32_32x32x16_bf16 v[144:159], v[24:27], v[36:39], v[144:159]
    s_lshl_b32 s72, s72, 1
    s_add_u32 s72, s72, s4
    s_lshl_b32 s79, s72, 2
    s_add_u32 s79, s79, 8192
    s_waitcnt lgkmcnt(10)
    v_mfma_f32_32x32x16_bf16 v[160:175], v[28:31], v[32:35], v[160:175]
    s_waitcnt lgkmcnt(0)
    v_mfma_f32_32x32x16_bf16 v[64:79], v[40:43], v[56:59], v[64:79]
    s_waitcnt lgkmcnt(0)
    s_barrier
    v_mfma_f32_32x32x16_bf16 v[80:95], v[40:43], v[60:63], v[80:95]
    ds_read_b128 v[32:35], v10 offset:16384
    ds_read_b64_tr_b16 v[16:17], v1 offset:43776
    v_mfma_f32_32x32x16_bf16 v[96:111], v[44:47], v[56:59], v[96:111]
    ds_read_b64_tr_b16 v[18:19], v1 offset:44672
    ds_read_b128 v[36:39], v11 offset:16384
    v_mfma_f32_32x32x16_bf16 v[112:127], v[44:47], v[60:63], v[112:127]
    ds_read_b64_tr_b16 v[20:21], v1 offset:43808
    ds_read_b64_tr_b16 v[22:23], v1 offset:44704
    v_mfma_f32_32x32x16_bf16 v[128:143], v[48:51], v[56:59], v[128:143]
    ds_read_b64_tr_b16 v[24:25], v1 offset:43840
    ds_read_b64_tr_b16 v[26:27], v1 offset:44736
    v_mfma_f32_32x32x16_bf16 v[144:159], v[48:51], v[60:63], v[144:159]
    ds_read_b64_tr_b16 v[28:29], v3 offset:43776
    ds_read_b64_tr_b16 v[30:31], v3 offset:44672
    v_mfma_f32_32x32x16_bf16 v[160:175], v[52:55], v[56:59], v[160:175]
    s_waitcnt lgkmcnt(7)
    v_mfma_f32_32x32x16_bf16 v[64:79], v[16:19], v[32:35], v[64:79]
    ds_read_b128 v[56:59], v12 offset:16384
    ds_read_b64_tr_b16 v[40:41], v2 offset:43776
    s_waitcnt vmcnt(5)
    v_cvt_pk_bf16_f32 v180, v176, v176
    v_cvt_pk_bf16_f32 v181, v177, v177
    s_waitcnt lgkmcnt(8)
    v_mfma_f32_32x32x16_bf16 v[80:95], v[16:19], v[36:39], v[80:95]
    ds_read_b64_tr_b16 v[42:43], v2 offset:44672
    ds_read_b128 v[60:63], v13 offset:16384
    v_cvt_pk_bf16_f32 v182, v178, v178
    v_cvt_pk_bf16_f32 v183, v179, v179
    v_lshlrev_b32 v180, 16, v180
    s_waitcnt lgkmcnt(8)
    v_mfma_f32_32x32x16_bf16 v[96:111], v[20:23], v[32:35], v[96:111]
    ds_read_b64_tr_b16 v[44:45], v2 offset:43808
    ds_read_b64_tr_b16 v[46:47], v2 offset:44704
    v_lshlrev_b32 v181, 16, v181
    v_lshlrev_b32 v182, 16, v182
    v_lshlrev_b32 v183, 16, v183
    v_mfma_f32_32x32x16_bf16 v[112:127], v[20:23], v[36:39], v[112:127]
    ds_read_b64_tr_b16 v[48:49], v2 offset:43840
    ds_read_b64_tr_b16 v[50:51], v2 offset:44736
    v_sub_f32 v180, v176, v180
    v_sub_f32 v181, v177, v181
    v_sub_f32 v182, v178, v182
    s_waitcnt lgkmcnt(10)
    v_mfma_f32_32x32x16_bf16 v[128:143], v[24:27], v[32:35], v[128:143]
    ds_read_b64_tr_b16 v[52:53], v4 offset:43776
    ds_read_b64_tr_b16 v[54:55], v4 offset:44672
    v_sub_f32 v183, v179, v183
    v_cvt_pk_bf16_f32 v192, v176, v180
    v_cvt_pk_bf16_f32 v196, v177, v181
    v_mfma_f32_32x32x16_bf16 v[144:159], v[24:27], v[36:39], v[144:159]
    v_cvt_pk_bf16_f32 v200, v178, v182
    v_cvt_pk_bf16_f32 v204, v179, v183
    s_waitcnt lgkmcnt(10)
    v_mfma_f32_32x32x16_bf16 v[160:175], v[28:31], v[32:35], v[160:175]
    s_waitcnt lgkmcnt(0)
    v_mfma_f32_32x32x16_bf16 v[64:79], v[40:43], v[56:59], v[64:79]
    s_barrier
    s_setprio 2
    v_mfma_f32_32x32x16_bf16 v[64:79], v[192:195], v[208:211], v[64:79]
    v_mfma_f32_32x32x16_bf16 v[80:95], v[40:43], v[60:63], v[80:95]
    v_mfma_f32_32x32x16_bf16 v[80:95], v[192:195], v[212:215], v[80:95]
    v_mfma_f32_32x32x16_bf16 v[96:111], v[44:47], v[56:59], v[96:111]
    v_mfma_f32_32x32x16_bf16 v[96:111], v[196:199], v[208:211], v[96:111]
    s_nop 7
    v_max_f32 v64, 0, v64
    v_max_f32 v65, 0, v65
    v_max_f32 v66, 0, v66
    v_max_f32 v67, 0, v67
    v_max_f32 v68, 0, v68
    v_max_f32 v69, 0, v69
    v_max_f32 v70, 0, v70
    v_max_f32 v71, 0, v71
    v_mul_f32 v64, v64, v72
    v_mul_f32 v65, v65, v73
    v_mul_f32 v66, v66, v74
    v_mul_f32 v67, v67, v75
    v_mul_f32 v68, v68, v76
    v_mul_f32 v69, v69, v77
    v_mul_f32 v70, v70, v78
    v_mul_f32 v71, v71, v79
    v_cvt_pk_bf16_f32 v16, v64, v65
    v_cvt_pk_bf16_f32 v17, v66, v67
    v_cvt_pk_bf16_f32 v18, v68, v69
    v_cvt_pk_bf16_f32 v19, v70, v71
    buffer_store_dwordx4 v[16:19], v9, s[40:43], s7 offen offset:0 sc1
    v_mfma_f32_32x32x16_bf16 v[112:127], v[44:47], v[60:63], v[112:127]
    v_mfma_f32_32x32x16_bf16 v[112:127], v[196:199], v[212:215], v[112:127]
    v_max_f32 v80, 0, v80
    v_max_f32 v81, 0, v81
    v_max_f32 v82, 0, v82
    v_max_f32 v83, 0, v83
    v_max_f32 v84, 0, v84
    v_max_f32 v85, 0, v85
    v_max_f32 v86, 0, v86
    v_max_f32 v87, 0, v87
    v_mul_f32 v80, v80, v88
    v_mul_f32 v81, v81, v89
    v_mul_f32 v82, v82, v90
    v_mul_f32 v83, v83, v91
    v_mul_f32 v84, v84, v92
    v_mul_f32 v85, v85, v93
    v_mul_f32 v86, v86, v94
    v_mul_f32 v87, v87, v95
    v_cvt_pk_bf16_f32 v20, v80, v81
    v_cvt_pk_bf16_f32 v21, v82, v83
    v_cvt_pk_bf16_f32 v22, v84, v85
    v_cvt_pk_bf16_f32 v23, v86, v87
    buffer_store_dwordx4 v[20:23], v9, s[40:43], s77 offen offset:0 sc1
    v_mfma_f32_32x32x16_bf16 v[128:143], v[48:51], v[56:59], v[128:143]
    v_mfma_f32_32x32x16_bf16 v[128:143], v[200:203], v[208:211], v[128:143]
    v_max_f32 v96, 0, v96
    v_max_f32 v97, 0, v97
    v_max_f32 v98, 0, v98
    v_max_f32 v99, 0, v99
    v_max_f32 v100, 0, v100
    v_max_f32 v101, 0, v101
    v_max_f32 v102, 0, v102
    v_max_f32 v103, 0, v103
    v_mul_f32 v96, v96, v104
    v_mul_f32 v97, v97, v105
    v_mul_f32 v98, v98, v106
    v_mul_f32 v99, v99, v107
    v_mul_f32 v100, v100, v108
    v_mul_f32 v101, v101, v109
    v_mul_f32 v102, v102, v110
    v_mul_f32 v103, v103, v111
    v_cvt_pk_bf16_f32 v24, v96, v97
    v_cvt_pk_bf16_f32 v25, v98, v99
    v_cvt_pk_bf16_f32 v26, v100, v101
    v_cvt_pk_bf16_f32 v27, v102, v103
    buffer_store_dwordx4 v[24:27], v9, s[40:43], s7 offen offset:512 sc1
    v_mfma_f32_32x32x16_bf16 v[144:159], v[48:51], v[60:63], v[144:159]
    v_mfma_f32_32x32x16_bf16 v[144:159], v[200:203], v[212:215], v[144:159]
    v_max_f32 v112, 0, v112
    v_max_f32 v113, 0, v113
    v_max_f32 v114, 0, v114
    v_max_f32 v115, 0, v115
    v_max_f32 v116, 0, v116
    v_max_f32 v117, 0, v117
    v_max_f32 v118, 0, v118
    v_max_f32 v119, 0, v119
    v_mul_f32 v112, v112, v120
    v_mul_f32 v113, v113, v121
    v_mul_f32 v114, v114, v122
    v_mul_f32 v115, v115, v123
    v_mul_f32 v116, v116, v124
    v_mul_f32 v117, v117, v125
    v_mul_f32 v118, v118, v126
    v_mul_f32 v119, v119, v127
    v_cvt_pk_bf16_f32 v16, v112, v113
    v_cvt_pk_bf16_f32 v17, v114, v115
    v_cvt_pk_bf16_f32 v18, v116, v117
    v_cvt_pk_bf16_f32 v19, v118, v119
    buffer_store_dwordx4 v[16:19], v9, s[40:43], s77 offen offset:512 sc1
    v_mfma_f32_32x32x16_bf16 v[160:175], v[52:55], v[56:59], v[160:175]
    v_mfma_f32_32x32x16_bf16 v[160:175], v[204:207], v[208:211], v[160:175]
    v_max_f32 v128, 0, v128
    v_max_f32 v129, 0, v129
    v_max_f32 v130, 0, v130
    v_max_f32 v131, 0, v131
    v_max_f32 v132, 0, v132
    v_max_f32 v133, 0, v133
    v_max_f32 v134, 0, v134
    v_max_f32 v135, 0, v135
    v_mul_f32 v128, v128, v136
    v_mul_f32 v129, v129, v137
    v_mul_f32 v130, v130, v138
    v_mul_f32 v131, v131, v139
    v_mul_f32 v132, v132, v140
    v_mul_f32 v133, v133, v141
    v_mul_f32 v134, v134, v142
    v_mul_f32 v135, v135, v143
    v_cvt_pk_bf16_f32 v20, v128, v129
    v_cvt_pk_bf16_f32 v21, v130, v131
    v_cvt_pk_bf16_f32 v22, v132, v133
    v_cvt_pk_bf16_f32 v23, v134, v135
    buffer_store_dwordx4 v[20:23], v9, s[40:43], s7 offen offset:1024 sc1
    v_max_f32 v144, 0, v144
    v_max_f32 v145, 0, v145
    v_max_f32 v146, 0, v146
    v_max_f32 v147, 0, v147
    v_max_f32 v148, 0, v148
    v_max_f32 v149, 0, v149
    v_max_f32 v150, 0, v150
    v_max_f32 v151, 0, v151
    v_mul_f32 v144, v144, v152
    v_mul_f32 v145, v145, v153
    v_mul_f32 v146, v146, v154
    v_mul_f32 v147, v147, v155
    v_mul_f32 v148, v148, v156
    v_mul_f32 v149, v149, v157
    v_mul_f32 v150, v150, v158
    v_mul_f32 v151, v151, v159
    v_cvt_pk_bf16_f32 v24, v144, v145
    v_cvt_pk_bf16_f32 v25, v146, v147
    v_cvt_pk_bf16_f32 v26, v148, v149
    v_cvt_pk_bf16_f32 v27, v150, v151
    buffer_store_dwordx4 v[24:27], v9, s[40:43], s77 offen offset:1024 sc1
    v_max_f32 v160, 0, v160
    v_max_f32 v161, 0, v161
    v_max_f32 v162, 0, v162
    v_max_f32 v163, 0, v163
    v_max_f32 v164, 0, v164
    v_max_f32 v165, 0, v165
    v_max_f32 v166, 0, v166
    v_max_f32 v167, 0, v167
    v_mul_f32 v160, v160, v168
    v_mul_f32 v161, v161, v169
    v_mul_f32 v162, v162, v170
    v_mul_f32 v163, v163, v171
    v_mul_f32 v164, v164, v172
    v_mul_f32 v165, v165, v173
    v_mul_f32 v166, v166, v174
    v_mul_f32 v167, v167, v175
    v_cvt_pk_bf16_f32 v16, v160, v161
    v_cvt_pk_bf16_f32 v17, v162, v163
    v_cvt_pk_bf16_f32 v18, v164, v165
    v_cvt_pk_bf16_f32 v19, v166, v167
    v_and_b32 v16, s101, v16
    v_and_b32 v17, s101, v17
    v_and_b32 v18, s101, v18
    v_and_b32 v19, s101, v19
    buffer_store_dwordx4 v[16:19], v9, s[40:43], s78 offen offset:0 sc1
    v_mov_b32 v6, v216
    v_mov_b32 v7, v217
    v_mov_b32 v8, v218
    v_mov_b32 v9, v219
    v_mov_b32 v10, v220
    v_mov_b32 v11, v221
    v_lshlrev_b32 v3, 4, v0
    s_waitcnt vmcnt(0)
    v_mov_b32 v4, s66
    v_mov_b32 v5, 0
    s_mov_b64 exec, 1
    buffer_store_dword v4, v5, s[40:43], s79 offen sc0 sc1
    s_mov_b64 exec, -1
    s_setprio 0
    s_add_u32 m0, s5, 20480
    s_nop 0
    buffer_load_dwordx4 v6, s[48:51], s6 offen offset:0 lds
    buffer_load_dwordx4 v7, s[48:51], s6 offen offset:1024 lds
    buffer_load_dwordx4 v8, s[48:51], s6 offen offset:2048 lds
    buffer_load_dwordx4 v9, s[48:51], s6 offen offset:3072 lds
    s_add_u32 m0, s5, 24576
    s_nop 0
    buffer_load_dwordx4 v10, s[48:51], s6 offen offset:0 lds
    s_add_u32 s6, s6, 40960
    s_cmp_eq_u32 s6, s100
    s_cselect_b32 s6, s99, s6
    s_add_u32 m0, s5, 40960
    s_nop 0
    buffer_load_dwordx4 v6, s[48:51], s6 offen offset:0 lds
    buffer_load_dwordx4 v7, s[48:51], s6 offen offset:1024 lds
    buffer_load_dwordx4 v8, s[48:51], s6 offen offset:2048 lds
    buffer_load_dwordx4 v9, s[48:51], s6 offen offset:3072 lds
    s_add_u32 m0, s5, 45056
    s_nop 0
    buffer_load_dwordx4 v10, s[48:51], s6 offen offset:0 lds
    s_add_u32 s6, s6, 40960
    s_cmp_eq_u32 s6, s100
    s_cselect_b32 s6, s99, s6
    s_add_u32 m0, s5, 61440
    s_nop 0
    buffer_load_dwordx4 v6, s[48:51], s6 offen offset:0 lds
    buffer_load_dwordx4 v7, s[48:51], s6 offen offset:1024 lds
    buffer_load_dwordx4 v8, s[48:51], s6 offen offset:2048 lds
    buffer_load_dwordx4 v9, s[48:51], s6 offen offset:3072 lds
    s_add_u32 m0, s5, 65536
    s_nop 0
    buffer_load_dwordx4 v10, s[48:51], s6 offen offset:0 lds
    s_add_u32 s6, s6, 40960
    s_cmp_eq_u32 s6, s100
    s_cselect_b32 s6, s99, s6
    ds_read_b64_tr_b16 v[156:157], v11 offset:0
    ds_read_b64_tr_b16 v[158:159], v11 offset:1280
    ds_read_b64_tr_b16 v[160:161], v11 offset:32
    ds_read_b64_tr_b16 v[162:163], v11 offset:1312
    ds_read_b64_tr_b16 v[164:165], v11 offset:64
    ds_read_b64_tr_b16 v[166:167], v11 offset:1344
    ds_read_b64_tr_b16 v[168:169], v11 offset:96
    ds_read_b64_tr_b16 v[170:171], v11 offset:1376
    ds_read_b64_tr_b16 v[172:173], v11 offset:128
    ds_read_b64_tr_b16 v[174:175], v11 offset:1408
    s_waitcnt lgkmcnt(0)
    s_add_u32 m0, s5, 0
    s_nop 0
    buffer_load_dwordx4 v6, s[48:51], s6 offen offset:0 lds
    buffer_load_dwordx4 v7, s[48:51], s6 offen offset:1024 lds
    buffer_load_dwordx4 v8, s[48:51], s6 offen offset:2048 lds
    buffer_load_dwordx4 v9, s[48:51], s6 offen offset:3072 lds
    s_add_u32 m0, s5, 4096
    s_nop 0
    buffer_load_dwordx4 v10, s[48:51], s6 offen offset:0 lds
    s_add_u32 s6, s6, 40960
    s_cmp_eq_u32 s6, s100
    s_cselect_b32 s6, s99, s6
    s_waitcnt vmcnt(15)
    ds_read_b64_tr_b16 v[176:177], v11 offset:20480
    ds_read_b64_tr_b16 v[178:179], v11 offset:21760
    ds_read_b64_tr_b16 v[180:181], v11 offset:20512
    ds_read_b64_tr_b16 v[182:183], v11 offset:21792
    ds_read_b64_tr_b16 v[184:185], v11 offset:20544
    ds_read_b64_tr_b16 v[186:187], v11 offset:21824
    ds_read_b64_tr_b16 v[188:189], v11 offset:20576
    ds_read_b64_tr_b16 v[190:191], v11 offset:21856
    ds_read_b64_tr_b16 v[192:193], v11 offset:20608
    ds_read_b64_tr_b16 v[194:195], v11 offset:21888
    s_waitcnt lgkmcnt(0)
    s_add_u32 m0, s5, 20480
    s_nop 0
    buffer_load_dwordx4 v6, s[48:51], s6 offen offset:0 lds
    buffer_load_dwordx4 v7, s[48:51], s6 offen offset:1024 lds
    buffer_load_dwordx4 v8, s[48:51], s6 offen offset:2048 lds
    buffer_load_dwordx4 v9, s[48:51], s6 offen offset:3072 lds
    s_add_u32 m0, s5, 24576
    s_nop 0
    buffer_load_dwordx4 v10, s[48:51], s6 offen offset:0 lds
    s_add_u32 s6, s6, 40960
    s_cmp_eq_u32 s6, s100
    s_cselect_b32 s6, s99, s6
    s_waitcnt vmcnt(15)
    ds_read_b64_tr_b16 v[196:197], v11 offset:40960
    ds_read_b64_tr_b16 v[198:199], v11 offset:42240
    ds_read_b64_tr_b16 v[200:201], v11 offset:40992
    ds_read_b64_tr_b16 v[202:203], v11 offset:42272
    ds_read_b64_tr_b16 v[204:205], v11 offset:41024
    ds_read_b64_tr_b16 v[206:207], v11 offset:42304
    ds_read_b64_tr_b16 v[208:209], v11 offset:41056
    ds_read_b64_tr_b16 v[210:211], v11 offset:42336
    ds_read_b64_tr_b16 v[212:213], v11 offset:41088
    ds_read_b64_tr_b16 v[214:215], v11 offset:42368
    s_waitcnt lgkmcnt(0)
    s_add_u32 m0, s5, 40960
    s_nop 0
    buffer_load_dwordx4 v6, s[48:51], s6 offen offset:0 lds
    buffer_load_dwordx4 v7, s[48:51], s6 offen offset:1024 lds
    buffer_load_dwordx4 v8, s[48:51], s6 offen offset:2048 lds
    buffer_load_dwordx4 v9, s[48:51], s6 offen offset:3072 lds
    s_add_u32 m0, s5, 45056
    s_nop 0
    buffer_load_dwordx4 v10, s[48:51], s6 offen offset:0 lds
    s_add_u32 s6, s6, 40960
    s_cmp_eq_u32 s6, s100
    s_cselect_b32 s6, s99, s6
    s_lshl_b32 s101, s75, 10
    s_lshl_b32 s75, s59, 4
    s_lshl_b32 s74, s57, 2
    s_add_u32 s75, s75, s74
    s_lshl_b32 s75, s75, 3
    s_add_u32 s75, s75, 8192
    v_and_b32 v5, 7, v0
    v_lshlrev_b32 v5, 2, v5
    buffer_load_dword v4, v5, s[40:43], s75 offen sc0 sc1
    s_waitcnt vmcnt(16)
    ds_read_b64_tr_b16 v[216:217], v11 offset:61440
    ds_read_b64_tr_b16 v[218:219], v11 offset:62720
    ds_read_b64_tr_b16 v[220:221], v11 offset:61472
    ds_read_b64_tr_b16 v[222:223], v11 offset:62752
    ds_read_b64_tr_b16 v[224:225], v11 offset:61504
    ds_read_b64_tr_b16 v[226:227], v11 offset:62784
    ds_read_b64_tr_b16 v[228:229], v11 offset:61536
    ds_read_b64_tr_b16 v[230:231], v11 offset:62816
    ds_read_b64_tr_b16 v[232:233], v11 offset:61568
    ds_read_b64_tr_b16 v[234:235], v11 offset:62848
    s_waitcnt lgkmcnt(0)
    s_add_u32 m0, s5, 61440
    s_nop 0
    buffer_load_dwordx4 v6, s[48:51], s6 offen offset:0 lds
    buffer_load_dwordx4 v7, s[48:51], s6 offen offset:1024 lds
    buffer_load_dwordx4 v8, s[48:51], s6 offen offset:2048 lds
    buffer_load_dwordx4 v9, s[48:51], s6 offen offset:3072 lds
    s_add_u32 m0, s5, 65536
    s_nop 0
    buffer_load_dwordx4 v10, s[48:51], s6 offen offset:0 lds
    s_add_u32 s6, s6, 40960
    s_cmp_eq_u32 s6, s100
    s_cselect_b32 s6, s99, s6
    s_waitcnt vmcnt(16)
    ds_read_b64_tr_b16 v[236:237], v11 offset:0
    ds_read_b64_tr_b16 v[238:239], v11 offset:1280
    ds_read_b64_tr_b16 v[240:241], v11 offset:32
    ds_read_b64_tr_b16 v[242:243], v11 offset:1312
    ds_read_b64_tr_b16 v[244:245], v11 offset:64
    ds_read_b64_tr_b16 v[246:247], v11 offset:1344
    ds_read_b64_tr_b16 v[248:249], v11 offset:96
    ds_read_b64_tr_b16 v[250:251], v11 offset:1376
    ds_read_b64_tr_b16 v[252:253], v11 offset:128
    ds_read_b64_tr_b16 v[254:255], v11 offset:1408
    s_waitcnt lgkmcnt(0)
    s_add_u32 m0, s5, 0
    s_nop 0
    buffer_load_dwordx4 v6, s[48:51], s6 offen offset:0 lds
    buffer_load_dwordx4 v7, s[48:51], s6 offen offset:1024 lds
    buffer_load_dwordx4 v8, s[48:51], s6 offen offset:2048 lds
    buffer_load_dwordx4 v9, s[48:51], s6 offen offset:3072 lds
    s_add_u32 m0, s5, 4096
    s_nop 0
    buffer_load_dwordx4 v10, s[48:51], s6 offen offset:0 lds
    s_add_u32 s6, s6, 40960
    s_cmp_eq_u32 s6, s100
    s_cselect_b32 s6, s99, s6
    s_add_u32 s73, s57, 0
    s_and_b32 s73, s73, 3
    s_lshl_b32 s74, s59, 2
    s_add_u32 s73, s73, s74
    s_mul_i32 s73, s73, 57344
    s_mul_i32 s74, s57, 14336
    s_add_u32 s73, s73, s74
    s_add_u32 s7, s73, 5332992
    s_add_u32 s73, s57, 1
    s_and_b32 s73, s73, 3
    s_lshl_b32 s74, s59, 2
    s_add_u32 s73, s73, s74
    s_mul_i32 s73, s73, 57344
    s_mul_i32 s74, s57, 14336
    s_add_u32 s73, s73, s74
    s_add_u32 s77, s73, 5332992
    s_add_u32 s73, s57, 2
    s_and_b32 s73, s73, 3
    s_lshl_b32 s74, s59, 2
    s_add_u32 s73, s73, s74
    s_mul_i32 s73, s73, 57344
    s_mul_i32 s74, s57, 14336
    s_add_u32 s73, s73, s74
    s_add_u32 s78, s73, 5332992
    s_add_u32 s73, s57, 3
    s_and_b32 s73, s73, 3
    s_lshl_b32 s74, s59, 2
    s_add_u32 s73, s73, s74
    s_mul_i32 s73, s73, 57344
    s_mul_i32 s74, s57, 14336
    s_add_u32 s73, s73, s74
    s_add_u32 s79, s73, 5332992
    s_waitcnt vmcnt(10)
    v_cmp_ne_u32 vcc, s66, v4
    s_cbranch_vccz L_hok
    s_mov_b32 s76, 262144
L_pollb_15:
    buffer_load_dword v4, v5, s[40:43], s75 offen sc0 sc1
    s_waitcnt vmcnt(0)
    v_cmp_ne_u32 vcc, s66, v4
    s_cbranch_vccz L_pollb_ok_16
    s_sub_u32 s76, s76, 1
    s_cmp_lg_u32 s76, 0
    s_cbranch_scc1 L_pollb_15
L_pollb_ok_16:
L_hok:
    s_add_u32 s69, s7, s101
    buffer_load_dwordx4 v[12:15], v3, s[40:43], s69 offen sc1
    s_add_u32 s69, s77, s101
    buffer_load_dwordx4 v[16:19], v3, s[40:43], s69 offen sc1
    s_add_u32 s69, s78, s101
    buffer_load_dwordx4 v[20:23], v3, s[40:43], s69 offen sc1
    s_add_u32 s69, s79, s101
    buffer_load_dwordx4 v[24:27], v3, s[40:43], s69 offen sc1
    s_add_u32 s101, s101, 1024
    s_cmp_eq_u32 s101, 14336
    s_cselect_b32 s101, 0, s101
    s_add_u32 s69, s7, s101
    buffer_load_dwordx4 v[28:31], v3, s[40:43], s69 offen sc1
    s_add_u32 s69, s77, s101
    buffer_load_dwordx4 v[32:35], v3, s[40:43], s69 offen sc1
    s_add_u32 s69, s78, s101
    buffer_load_dwordx4 v[36:39], v3, s[40:43], s69 offen sc1
    s_add_u32 s69, s79, s101
    buffer_load_dwordx4 v[40:43], v3, s[40:43], s69 offen sc1
    s_add_u32 s101, s101, 1024
    s_cmp_eq_u32 s101, 14336
    s_cselect_b32 s101, 0, s101
    s_add_u32 s69, s7, s101
    buffer_load_dwordx4 v[44:47], v3, s[40:43], s69 offen sc1
    s_add_u32 s69, s77, s101
    buffer_load_dwordx4 v[48:51], v3, s[40:43], s69 offen sc1
    s_add_u32 s69, s78, s101
    buffer_load_dwordx4 v[52:55], v3, s[40:43], s69 offen sc1
    s_add_u32 s69, s79, s101
    buffer_load_dwordx4 v[56:59], v3, s[40:43], s69 offen sc1
    s_add_u32 s101, s101, 1024
    s_cmp_eq_u32 s101, 14336
    s_cselect_b32 s101, 0, s101
    s_add_u32 s69, s7, s101
    buffer_load_dwordx4 v[60:63], v3, s[40:43], s69 offen sc1
    s_add_u32 s69, s77, s101
    buffer_load_dwordx4 v[64:67], v3, s[40:43], s69 offen sc1
    s_add_u32 s69, s78, s101
    buffer_load_dwordx4 v[68:71], v3, s[40:43], s69 offen sc1
    s_add_u32 s69, s79, s101
    buffer_load_dwordx4 v[72:75], v3, s[40:43], s69 offen sc1
    s_add_u32 s101, s101, 1024
    s_cmp_eq_u32 s101, 14336
    s_cselect_b32 s101, 0, s101
    s_waitcnt vmcnt(15)
    v_mfma_f32_16x16x32_bf16 v[76:79], v[156:159], v[12:15], 0
    v_mfma_f32_16x16x32_bf16 v[80:83], v[160:163], v[12:15], 0
    v_mfma_f32_16x16x32_bf16 v[84:87], v[164:167], v[12:15], 0
    v_mfma_f32_16x16x32_bf16 v[88:91], v[168:171], v[12:15], 0
    v_mfma_f32_16x16x32_bf16 v[92:95], v[172:175], v[12:15], 0
    s_add_u32 s69, s7, s101
    buffer_load_dwordx4 v[12:15], v3, s[40:43], s69 offen sc1
    s_waitcnt vmcnt(15)
    v_mfma_f32_16x16x32_bf16 v[96:99], v[156:159], v[16:19], 0
    v_mfma_f32_16x16x32_bf16 v[100:103], v[160:163], v[16:19], 0
    v_mfma_f32_16x16x32_bf16 v[104:107], v[164:167], v[16:19], 0
    v_mfma_f32_16x16x32_bf16 v[108:111], v[168:171], v[16:19], 0
    v_mfma_f32_16x16x32_bf16 v[112:115], v[172:175], v[16:19], 0
    s_add_u32 s69, s77, s101
    buffer_load_dwordx4 v[16:19], v3, s[40:43], s69 offen sc1
    s_waitcnt vmcnt(15)
    v_mfma_f32_16x16x32_bf16 v[116:119], v[156:159], v[20:23], 0
    v_mfma_f32_16x16x32_bf16 v[120:123], v[160:163], v[20:23], 0
    v_mfma_f32_16x16x32_bf16 v[124:127], v[164:167], v[20:23], 0
    v_mfma_f32_16x16x32_bf16 v[128:131], v[168:171], v[20:23], 0
    v_mfma_f32_16x16x32_bf16 v[132:135], v[172:175], v[20:23], 0
    s_add_u32 s69, s78, s101
    buffer_load_dwordx4 v[20:23], v3, s[40:43], s69 offen sc1
    s_waitcnt vmcnt(15)
    v_mfma_f32_16x16x32_bf16 v[136:139], v[156:159], v[24:27], 0
    v_mfma_f32_16x16x32_bf16 v[140:143], v[160:163], v[24:27], 0
    v_mfma_f32_16x16x32_bf16 v[144:147], v[164:167], v[24:27], 0
    v_mfma_f32_16x16x32_bf16 v[148:151], v[168:171], v[24:27], 0
    v_mfma_f32_16x16x32_bf16 v[152:155], v[172:175], v[24:27], 0
    s_add_u32 s69, s79, s101
    buffer_load_dwordx4 v[24:27], v3, s[40:43], s69 offen sc1
    s_add_u32 s101, s101, 1024
    s_cmp_eq_u32 s101, 14336
    s_cselect_b32 s101, 0, s101
    s_waitcnt vmcnt(15)
    v_mfma_f32_16x16x32_bf16 v[76:79], v[176:179], v[28:31], v[76:79]
    v_mfma_f32_16x16x32_bf16 v[80:83], v[180:183], v[28:31], v[80:83]
    ds_read_b64_tr_b16 v[156:157], v11 offset:20480
    v_mfma_f32_16x16x32_bf16 v[84:87], v[184:187], v[28:31], v[84:87]
    ds_read_b64_tr_b16 v[158:159], v11 offset:21760
    v_mfma_f32_16x16x32_bf16 v[88:91], v[188:191], v[28:31], v[88:91]
    ds_read_b64_tr_b16 v[160:161], v11 offset:20512
    v_mfma_f32_16x16x32_bf16 v[92:95], v[192:195], v[28:31], v[92:95]
    ds_read_b64_tr_b16 v[162:163], v11 offset:21792
    s_add_u32 s69, s7, s101
    buffer_load_dwordx4 v[28:31], v3, s[40:43], s69 offen sc1
    s_waitcnt vmcnt(15)
    v_mfma_f32_16x16x32_bf16 v[96:99], v[176:179], v[32:35], v[96:99]
    ds_read_b64_tr_b16 v[164:165], v11 offset:20544
    v_mfma_f32_16x16x32_bf16 v[100:103], v[180:183], v[32:35], v[100:103]
    ds_read_b64_tr_b16 v[166:167], v11 offset:21824
    v_mfma_f32_16x16x32_bf16 v[104:107], v[184:187], v[32:35], v[104:107]
    ds_read_b64_tr_b16 v[168:169], v11 offset:20576
    v_mfma_f32_16x16x32_bf16 v[108:111], v[188:191], v[32:35], v[108:111]
    ds_read_b64_tr_b16 v[170:171], v11 offset:21856
    v_mfma_f32_16x16x32_bf16 v[112:115], v[192:195], v[32:35], v[112:115]
    ds_read_b64_tr_b16 v[172:173], v11 offset:20608
    s_add_u32 s69, s77, s101
    buffer_load_dwordx4 v[32:35], v3, s[40:43], s69 offen sc1
    s_waitcnt vmcnt(15)
    v_mfma_f32_16x16x32_bf16 v[116:119], v[176:179], v[36:39], v[116:119]
    ds_read_b64_tr_b16 v[174:175], v11 offset:21888
    v_mfma_f32_16x16x32_bf16 v[120:123], v[180:183], v[36:39], v[120:123]
    v_mfma_f32_16x16x32_bf16 v[124:127], v[184:187], v[36:39], v[124:127]
    v_mfma_f32_16x16x32_bf16 v[128:131], v[188:191], v[36:39], v[128:131]
    v_mfma_f32_16x16x32_bf16 v[132:135], v[192:195], v[36:39], v[132:135]
    s_waitcnt lgkmcnt(0)
    s_add_u32 m0, s5, 20480
    s_nop 0
    buffer_load_dwordx4 v6, s[48:51], s6 offen offset:0 lds
    s_add_u32 s69, s78, s101
    buffer_load_dwordx4 v[36:39], v3, s[40:43], s69 offen sc1
    s_waitcnt vmcnt(16)
    v_mfma_f32_16x16x32_bf16 v[136:139], v[176:179], v[40:43], v[136:139]
    buffer_load_dwordx4 v7, s[48:51], s6 offen offset:1024 lds
    v_mfma_f32_16x16x32_bf16 v[140:143], v[180:183], v[40:43], v[140:143]
    buffer_load_dwordx4 v8, s[48:51], s6 offen offset:2048 lds
    v_mfma_f32_16x16x32_bf16 v[144:147], v[184:187], v[40:43], v[144:147]
    buffer_load_dwordx4 v9, s[48:51], s6 offen offset:3072 lds
    v_mfma_f32_16x16x32_bf16 v[148:151], v[188:191], v[40:43], v[148:151]
    s_add_u32 m0, s5, 24576
    s_nop 0
    buffer_load_dwordx4 v10, s[48:51], s6 offen offset:0 lds
    s_add_u32 s6, s6, 40960
    s_cmp_eq_u32 s6, s100
    s_cselect_b32 s6, s99, s6
    v_mfma_f32_16x16x32_bf16 v[152:155], v[192:195], v[40:43], v[152:155]
    s_add_u32 s69, s79, s101
    buffer_load_dwordx4 v[40:43], v3, s[40:43], s69 offen sc1
    s_add_u32 s101, s101, 1024
    s_cmp_eq_u32 s101, 14336
    s_cselect_b32 s101, 0, s101
    s_waitcnt vmcnt(20)
    v_mfma_f32_16x16x32_bf16 v[76:79], v[196:199], v[44:47], v[76:79]
    v_mfma_f32_16x16x32_bf16 v[80:83], v[200:203], v[44:47], v[80:83]
    ds_read_b64_tr_b16 v[176:177], v11 offset:40960
    v_mfma_f32_16x16x32_bf16 v[84:87], v[204:207], v[44:47], v[84:87]
    ds_read_b64_tr_b16 v[178:179], v11 offset:42240
    v_mfma_f32_16x16x32_bf16 v[88:91], v[208:211], v[44:47], v[88:91]
    ds_read_b64_tr_b16 v[180:181], v11 offset:40992
    v_mfma_f32_16x16x32_bf16 v[92:95], v[212:215], v[44:47], v[92:95]
    ds_read_b64_tr_b16 v[182:183], v11 offset:42272
    s_add_u32 s69, s7, s101
    buffer_load_dwordx4 v[44:47], v3, s[40:43], s69 offen sc1
    s_waitcnt vmcnt(20)
    v_mfma_f32_16x16x32_bf16 v[96:99], v[196:199], v[48:51], v[96:99]
    ds_read_b64_tr_b16 v[184:185], v11 offset:41024
    v_mfma_f32_16x16x32_bf16 v[100:103], v[200:203], v[48:51], v[100:103]
    ds_read_b64_tr_b16 v[186:187], v11 offset:42304
    v_mfma_f32_16x16x32_bf16 v[104:107], v[204:207], v[48:51], v[104:107]
    ds_read_b64_tr_b16 v[188:189], v11 offset:41056
    v_mfma_f32_16x16x32_bf16 v[108:111], v[208:211], v[48:51], v[108:111]
    ds_read_b64_tr_b16 v[190:191], v11 offset:42336
    v_mfma_f32_16x16x32_bf16 v[112:115], v[212:215], v[48:51], v[112:115]
    ds_read_b64_tr_b16 v[192:193], v11 offset:41088
    s_add_u32 s69, s77, s101
    buffer_load_dwordx4 v[48:51], v3, s[40:43], s69 offen sc1
    s_waitcnt vmcnt(20)
    v_mfma_f32_16x16x32_bf16 v[116:119], v[196:199], v[52:55], v[116:119]
    ds_read_b64_tr_b16 v[194:195], v11 offset:42368
    v_mfma_f32_16x16x32_bf16 v[120:123], v[200:203], v[52:55], v[120:123]
    v_mfma_f32_16x16x32_bf16 v[124:127], v[204:207], v[52:55], v[124:127]
    v_mfma_f32_16x16x32_bf16 v[128:131], v[208:211], v[52:55], v[128:131]
    v_mfma_f32_16x16x32_bf16 v[132:135], v[212:215], v[52:55], v[132:135]
    s_waitcnt lgkmcnt(0)
    s_add_u32 m0, s5, 40960
    s_nop 0
    buffer_load_dwordx4 v6, s[48:51], s6 offen offset:0 lds
    s_add_u32 s69, s78, s101
    buffer_load_dwordx4 v[52:55], v3, s[40:43], s69 offen sc1
    s_waitcnt vmcnt(21)
    v_mfma_f32_16x16x32_bf16 v[136:139], v[196:199], v[56:59], v[136:139]
    buffer_load_dwordx4 v7, s[48:51], s6 offen offset:1024 lds
    v_mfma_f32_16x16x32_bf16 v[140:143], v[200:203], v[56:59], v[140:143]
    buffer_load_dwordx4 v8, s[48:51], s6 offen offset:2048 lds
    v_mfma_f32_16x16x32_bf16 v[144:147], v[204:207], v[56:59], v[144:147]
    buffer_load_dwordx4 v9, s[48:51], s6 offen offset:3072 lds
    v_mfma_f32_16x16x32_bf16 v[148:151], v[208:211], v[56:59], v[148:151]
    s_add_u32 m0, s5, 45056
    s_nop 0
    buffer_load_dwordx4 v10, s[48:51], s6 offen offset:0 lds
    s_add_u32 s6, s6, 40960
    s_cmp_eq_u32 s6, s100
    s_cselect_b32 s6, s99, s6
    v_mfma_f32_16x16x32_bf16 v[152:155], v[212:215], v[56:59], v[152:155]
    s_add_u32 s69, s79, s101
    buffer_load_dwordx4 v[56:59], v3, s[40:43], s69 offen sc1
    s_add_u32 s101, s101, 1024
    s_cmp_eq_u32 s101, 14336
    s_cselect_b32 s101, 0, s101
    s_waitcnt vmcnt(25)
    v_mfma_f32_16x16x32_bf16 v[76:79], v[216:219], v[60:63], v[76:79]
    v_mfma_f32_16x16x32_bf16 v[80:83], v[220:223], v[60:63], v[80:83]
    ds_read_b64_tr_b16 v[196:197], v11 offset:61440
    v_mfma_f32_16x16x32_bf16 v[84:87], v[224:227], v[60:63], v[84:87]
    ds_read_b64_tr_b16 v[198:199], v11 offset:62720
    v_mfma_f32_16x16x32_bf16 v[88:91], v[228:231], v[60:63], v[88:91]
    ds_read_b64_tr_b16 v[200:201], v11 offset:61472
    v_mfma_f32_16x16x32_bf16 v[92:95], v[232:235], v[60:63], v[92:95]
    ds_read_b64_tr_b16 v[202:203], v11 offset:62752
    s_add_u32 s69, s7, s101
    buffer_load_dwordx4 v[60:63], v3, s[40:43], s69 offen sc1
    s_waitcnt vmcnt(25)
    v_mfma_f32_16x16x32_bf16 v[96:99], v[216:219], v[64:67], v[96:99]
    ds_read_b64_tr_b16 v[204:205], v11 offset:61504
    v_mfma_f32_16x16x32_bf16 v[100:103], v[220:223], v[64:67], v[100:103]
    ds_read_b64_tr_b16 v[206:207], v11 offset:62784
    v_mfma_f32_16x16x32_bf16 v[104:107], v[224:227], v[64:67], v[104:107]
    ds_read_b64_tr_b16 v[208:209], v11 offset:61536
    v_mfma_f32_16x16x32_bf16 v[108:111], v[228:231], v[64:67], v[108:111]
    ds_read_b64_tr_b16 v[210:211], v11 offset:62816
    v_mfma_f32_16x16x32_bf16 v[112:115], v[232:235], v[64:67], v[112:115]
    ds_read_b64_tr_b16 v[212:213], v11 offset:61568
    s_add_u32 s69, s77, s101
    buffer_load_dwordx4 v[64:67], v3, s[40:43], s69 offen sc1
    s_waitcnt vmcnt(25)
    v_mfma_f32_16x16x32_bf16 v[116:119], v[216:219], v[68:71], v[116:119]
    ds_read_b64_tr_b16 v[214:215], v11 offset:62848
    v_mfma_f32_16x16x32_bf16 v[120:123], v[220:223], v[68:71], v[120:123]
    v_mfma_f32_16x16x32_bf16 v[124:127], v[224:227], v[68:71], v[124:127]
    v_mfma_f32_16x16x32_bf16 v[128:131], v[228:231], v[68:71], v[128:131]
    v_mfma_f32_16x16x32_bf16 v[132:135], v[232:235], v[68:71], v[132:135]
    s_waitcnt lgkmcnt(0)
    s_add_u32 m0, s5, 61440
    s_nop 0
    buffer_load_dwordx4 v6, s[48:51], s6 offen offset:0 lds
    s_add_u32 s69, s78, s101
    buffer_load_dwordx4 v[68:71], v3, s[40:43], s69 offen sc1
    s_waitcnt vmcnt(26)
    v_mfma_f32_16x16x32_bf16 v[136:139], v[216:219], v[72:75], v[136:139]
    buffer_load_dwordx4 v7, s[48:51], s6 offen offset:1024 lds
    v_mfma_f32_16x16x32_bf16 v[140:143], v[220:223], v[72:75], v[140:143]
    buffer_load_dwordx4 v8, s[48:51], s6 offen offset:2048 lds
    v_mfma_f32_16x16x32_bf16 v[144:147], v[224:227], v[72:75], v[144:147]
    buffer_load_dwordx4 v9, s[48:51], s6 offen offset:3072 lds
    v_mfma_f32_16x16x32_bf16 v[148:151], v[228:231], v[72:75], v[148:151]
    s_add_u32 m0, s5, 65536
    s_nop 0
    buffer_load_dwordx4 v10, s[48:51], s6 offen offset:0 lds
    s_add_u32 s6, s6, 40960
    s_cmp_eq_u32 s6, s100
    s_cselect_b32 s6, s99, s6
    v_mfma_f32_16x16x32_bf16 v[152:155], v[232:235], v[72:75], v[152:155]
    s_add_u32 s69, s79, s101
    buffer_load_dwordx4 v[72:75], v3, s[40:43], s69 offen sc1
    s_add_u32 s101, s101, 1024
    s_cmp_eq_u32 s101, 14336
    s_cselect_b32 s101, 0, s101
    s_waitcnt vmcnt(30)
    v_mfma_f32_16x16x32_bf16 v[76:79], v[236:239], v[12:15], v[76:79]
    v_mfma_f32_16x16x32_bf16 v[80:83], v[240:243], v[12:15], v[80:83]
    ds_read_b64_tr_b16 v[216:217], v11 offset:0
    v_mfma_f32_16x16x32_bf16 v[84:87], v[244:247], v[12:15], v[84:87]
    ds_read_b64_tr_b16 v[218:219], v11 offset:1280
    v_mfma_f32_16x16x32_bf16 v[88:91], v[248:251], v[12:15], v[88:91]
    ds_read_b64_tr_b16 v[220:221], v11 offset:32
    v_mfma_f32_16x16x32_bf16 v[92:95], v[252:255], v[12:15], v[92:95]
    ds_read_b64_tr_b16 v[222:223], v11 offset:1312
    s_add_u32 s69, s7, s101
    buffer_load_dwordx4 v[12:15], v3, s[40:43], s69 offen sc1
    s_waitcnt vmcnt(30)
    v_mfma_f32_16x16x32_bf16 v[96:99], v[236:239], v[16:19], v[96:99]
    ds_read_b64_tr_b16 v[224:225], v11 offset:64
    v_mfma_f32_16x16x32_bf16 v[100:103], v[240:243], v[16:19], v[100:103]
    ds_read_b64_tr_b16 v[226:227], v11 offset:1344
    v_mfma_f32_16x16x32_bf16 v[104:107], v[244:247], v[16:19], v[104:107]
    ds_read_b64_tr_b16 v[228:229], v11 offset:96
    v_mfma_f32_16x16x32_bf16 v[108:111], v[248:251], v[16:19], v[108:111]
    ds_read_b64_tr_b16 v[230:231], v11 offset:1376
    v_mfma_f32_16x16x32_bf16 v[112:115], v[252:255], v[16:19], v[112:115]
    ds_read_b64_tr_b16 v[232:233], v11 offset:128
    s_add_u32 s69, s77, s101
    buffer_load_dwordx4 v[16:19], v3, s[40:43], s69 offen sc1
    s_waitcnt vmcnt(30)
    v_mfma_f32_16x16x32_bf16 v[116:119], v[236:239], v[20:23], v[116:119]
    ds_read_b64_tr_b16 v[234:235], v11 offset:1408
    v_mfma_f32_16x16x32_bf16 v[120:123], v[240:243], v[20:23], v[120:123]
    v_mfma_f32_16x16x32_bf16 v[124:127], v[244:247], v[20:23], v[124:127]
    v_mfma_f32_16x16x32_bf16 v[128:131], v[248:251], v[20:23], v[128:131]
    v_mfma_f32_16x16x32_bf16 v[132:135], v[252:255], v[20:23], v[132:135]
    s_waitcnt lgkmcnt(0)
    s_add_u32 m0, s5, 0
    s_nop 0
    buffer_load_dwordx4 v6, s[48:51], s6 offen offset:0 lds
    s_add_u32 s69, s78, s101
    buffer_load_dwordx4 v[20:23], v3, s[40:43], s69 offen sc1
    s_waitcnt vmcnt(31)
    v_mfma_f32_16x16x32_bf16 v[136:139], v[236:239], v[24:27], v[136:139]
    buffer_load_dwordx4 v7, s[48:51], s6 offen offset:1024 lds
    v_mfma_f32_16x16x32_bf16 v[140:143], v[240:243], v[24:27], v[140:143]
    buffer_load_dwordx4 v8, s[48:51], s6 offen offset:2048 lds
    v_mfma_f32_16x16x32_bf16 v[144:147], v[244:247], v[24:27], v[144:147]
    buffer_load_dwordx4 v9, s[48:51], s6 offen offset:3072 lds
    v_mfma_f32_16x16x32_bf16 v[148:151], v[248:251], v[24:27], v[148:151]
    s_add_u32 m0, s5, 4096
    s_nop 0
    buffer_load_dwordx4 v10, s[48:51], s6 offen offset:0 lds
    s_add_u32 s6, s6, 40960
    s_cmp_eq_u32 s6, s100
    s_cselect_b32 s6, s99, s6
    v_mfma_f32_16x16x32_bf16 v[152:155], v[252:255], v[24:27], v[152:155]
    s_add_u32 s69, s79, s101
    buffer_load_dwordx4 v[24:27], v3, s[40:43], s69 offen sc1
    s_add_u32 s101, s101, 1024
    s_cmp_eq_u32 s101, 14336
    s_cselect_b32 s101, 0, s101
    s_waitcnt vmcnt(35)
    v_mfma_f32_16x16x32_bf16 v[76:79], v[156:159], v[28:31], v[76:79]
    s_waitcnt vmcnt(28)
    v_mfma_f32_16x16x32_bf16 v[80:83], v[160:163], v[28:31], v[80:83]
    ds_read_b64_tr_b16 v[236:237], v11 offset:20480
    v_mfma_f32_16x16x32_bf16 v[84:87], v[164:167], v[28:31], v[84:87]
    ds_read_b64_tr_b16 v[238:239], v11 offset:21760
    v_mfma_f32_16x16x32_bf16 v[88:91], v[168:171], v[28:31], v[88:91]
    ds_read_b64_tr_b16 v[240:241], v11 offset:20512
    v_mfma_f32_16x16x32_bf16 v[92:95], v[172:175], v[28:31], v[92:95]
    ds_read_b64_tr_b16 v[242:243], v11 offset:21792
    s_add_u32 s69, s7, s101
    buffer_load_dwordx4 v[28:31], v3, s[40:43], s69 offen sc1
    v_mfma_f32_16x16x32_bf16 v[96:99], v[156:159], v[32:35], v[96:99]
    ds_read_b64_tr_b16 v[244:245], v11 offset:20544
    v_mfma_f32_16x16x32_bf16 v[100:103], v[160:163], v[32:35], v[100:103]
    ds_read_b64_tr_b16 v[246:247], v11 offset:21824
    v_mfma_f32_16x16x32_bf16 v[104:107], v[164:167], v[32:35], v[104:107]
    ds_read_b64_tr_b16 v[248:249], v11 offset:20576
    v_mfma_f32_16x16x32_bf16 v[108:111], v[168:171], v[32:35], v[108:111]
    ds_read_b64_tr_b16 v[250:251], v11 offset:21856
    v_mfma_f32_16x16x32_bf16 v[112:115], v[172:175], v[32:35], v[112:115]
    ds_read_b64_tr_b16 v[252:253], v11 offset:20608
    s_add_u32 s69, s77, s101
    buffer_load_dwordx4 v[32:35], v3, s[40:43], s69 offen sc1
    v_mfma_f32_16x16x32_bf16 v[116:119], v[156:159], v[36:39], v[116:119]
    ds_read_b64_tr_b16 v[254:255], v11 offset:21888
    v_mfma_f32_16x16x32_bf16 v[120:123], v[160:163], v[36:39], v[120:123]
    v_mfma_f32_16x16x32_bf16 v[124:127], v[164:167], v[36:39], v[124:127]
    v_mfma_f32_16x16x32_bf16 v[128:131], v[168:171], v[36:39], v[128:131]
    v_mfma_f32_16x16x32_bf16 v[132:135], v[172:175], v[36:39], v[132:135]
    s_waitcnt lgkmcnt(0)
    s_add_u32 m0, s5, 20480
    s_nop 0
    buffer_load_dwordx4 v6, s[48:51], s6 offen offset:0 lds
    s_add_u32 s69, s78, s101
    buffer_load_dwordx4 v[36:39], v3, s[40:43], s69 offen sc1
    s_waitcnt vmcnt(31)
    v_mfma_f32_16x16x32_bf16 v[136:139], v[156:159], v[40:43], v[136:139]
    buffer_load_dwordx4 v7, s[48:51], s6 offen offset:1024 lds
    v_mfma_f32_16x16x32_bf16 v[140:143], v[160:163], v[40:43], v[140:143]
    buffer_load_dwordx4 v8, s[48:51], s6 offen offset:2048 lds
    v_mfma_f32_16x16x32_bf16 v[144:147], v[164:167], v[40:43], v[144:147]
    buffer_load_dwordx4 v9, s[48:51], s6 offen offset:3072 lds
    v_mfma_f32_16x16x32_bf16 v[148:151], v[168:171], v[40:43], v[148:151]
    s_add_u32 m0, s5, 24576
    s_nop 0
    buffer_load_dwordx4 v10, s[48:51], s6 offen offset:0 lds
    v_mfma_f32_16x16x32_bf16 v[152:155], v[172:175], v[40:43], v[152:155]
    s_add_u32 s69, s79, s101
    buffer_load_dwordx4 v[40:43], v3, s[40:43], s69 offen sc1
    s_add_u32 s101, s101, 1024
    s_cmp_eq_u32 s101, 14336
    s_cselect_b32 s101, 0, s101
    s_waitcnt vmcnt(35)
    v_mfma_f32_16x16x32_bf16 v[76:79], v[176:179], v[44:47], v[76:79]
    s_waitcnt vmcnt(28)
    v_mfma_f32_16x16x32_bf16 v[80:83], v[180:183], v[44:47], v[80:83]
    ds_read_b64_tr_b16 v[156:157], v11 offset:40960
    v_mfma_f32_16x16x32_bf16 v[84:87], v[184:187], v[44:47], v[84:87]
    ds_read_b64_tr_b16 v[158:159], v11 offset:42240
    v_mfma_f32_16x16x32_bf16 v[88:91], v[188:191], v[44:47], v[88:91]
    ds_read_b64_tr_b16 v[160:161], v11 offset:40992
    v_mfma_f32_16x16x32_bf16 v[92:95], v[192:195], v[44:47], v[92:95]
    ds_read_b64_tr_b16 v[162:163], v11 offset:42272
    s_add_u32 s69, s7, s101
    buffer_load_dwordx4 v[44:47], v3, s[40:43], s69 offen sc1
    v_mfma_f32_16x16x32_bf16 v[96:99], v[176:179], v[48:51], v[96:99]
    ds_read_b64_tr_b16 v[164:165], v11 offset:41024
    v_mfma_f32_16x16x32_bf16 v[100:103], v[180:183], v[48:51], v[100:103]
    ds_read_b64_tr_b16 v[166:167], v11 offset:42304
    v_mfma_f32_16x16x32_bf16 v[104:107], v[184:187], v[48:51], v[104:107]
    ds_read_b64_tr_b16 v[168:169], v11 offset:41056
    v_mfma_f32_16x16x32_bf16 v[108:111], v[188:191], v[48:51], v[108:111]
    ds_read_b64_tr_b16 v[170:171], v11 offset:42336
    v_mfma_f32_16x16x32_bf16 v[112:115], v[192:195], v[48:51], v[112:115]
    ds_read_b64_tr_b16 v[172:173], v11 offset:41088
    s_add_u32 s69, s77, s101
    buffer_load_dwordx4 v[48:51], v3, s[40:43], s69 offen sc1
    v_mfma_f32_16x16x32_bf16 v[116:119], v[176:179], v[52:55], v[116:119]
    ds_read_b64_tr_b16 v[174:175], v11 offset:42368
    v_mfma_f32_16x16x32_bf16 v[120:123], v[180:183], v[52:55], v[120:123]
    v_mfma_f32_16x16x32_bf16 v[124:127], v[184:187], v[52:55], v[124:127]
    v_mfma_f32_16x16x32_bf16 v[128:131], v[188:191], v[52:55], v[128:131]
    v_mfma_f32_16x16x32_bf16 v[132:135], v[192:195], v[52:55], v[132:135]
    s_add_u32 s69, s78, s101
    buffer_load_dwordx4 v[52:55], v3, s[40:43], s69 offen sc1
    s_waitcnt vmcnt(30)
    v_mfma_f32_16x16x32_bf16 v[136:139], v[176:179], v[56:59], v[136:139]
    v_mfma_f32_16x16x32_bf16 v[140:143], v[180:183], v[56:59], v[140:143]
    v_mfma_f32_16x16x32_bf16 v[144:147], v[184:187], v[56:59], v[144:147]
    v_mfma_f32_16x16x32_bf16 v[148:151], v[188:191], v[56:59], v[148:151]
    v_mfma_f32_16x16x32_bf16 v[152:155], v[192:195], v[56:59], v[152:155]
    s_add_u32 s69, s79, s101
    buffer_load_dwordx4 v[56:59], v3, s[40:43], s69 offen sc1
    s_add_u32 s101, s101, 1024
    s_cmp_eq_u32 s101, 14336
    s_cselect_b32 s101, 0, s101
    s_waitcnt vmcnt(30)
    v_mfma_f32_16x16x32_bf16 v[76:79], v[196:199], v[60:63], v[76:79]
    s_waitcnt vmcnt(23)
    v_mfma_f32_16x16x32_bf16 v[80:83], v[200:203], v[60:63], v[80:83]
    ds_read_b64_tr_b16 v[176:177], v11 offset:61440
    v_mfma_f32_16x16x32_bf16 v[84:87], v[204:207], v[60:63], v[84:87]
    ds_read_b64_tr_b16 v[178:179], v11 offset:62720
    v_mfma_f32_16x16x32_bf16 v[88:91], v[208:211], v[60:63], v[88:91]
    ds_read_b64_tr_b16 v[180:181], v11 offset:61472
    v_mfma_f32_16x16x32_bf16 v[92:95], v[212:215], v[60:63], v[92:95]
    ds_read_b64_tr_b16 v[182:183], v11 offset:62752
    s_add_u32 s69, s7, s101
    buffer_load_dwordx4 v[60:63], v3, s[40:43], s69 offen sc1
    v_mfma_f32_16x16x32_bf16 v[96:99], v[196:199], v[64:67], v[96:99]
    ds_read_b64_tr_b16 v[184:185], v11 offset:61504
    v_mfma_f32_16x16x32_bf16 v[100:103], v[200:203], v[64:67], v[100:103]
    ds_read_b64_tr_b16 v[186:187], v11 offset:62784
    v_mfma_f32_16x16x32_bf16 v[104:107], v[204:207], v[64:67], v[104:107]
    ds_read_b64_tr_b16 v[188:189], v11 offset:61536
    v_mfma_f32_16x16x32_bf16 v[108:111], v[208:211], v[64:67], v[108:111]
    ds_read_b64_tr_b16 v[190:191], v11 offset:62816
    v_mfma_f32_16x16x32_bf16 v[112:115], v[212:215], v[64:67], v[112:115]
    ds_read_b64_tr_b16 v[192:193], v11 offset:61568
    s_add_u32 s69, s77, s101
    buffer_load_dwordx4 v[64:67], v3, s[40:43], s69 offen sc1
    v_mfma_f32_16x16x32_bf16 v[116:119], v[196:199], v[68:71], v[116:119]
    ds_read_b64_tr_b16 v[194:195], v11 offset:62848
    v_mfma_f32_16x16x32_bf16 v[120:123], v[200:203], v[68:71], v[120:123]
    v_mfma_f32_16x16x32_bf16 v[124:127], v[204:207], v[68:71], v[124:127]
    v_mfma_f32_16x16x32_bf16 v[128:131], v[208:211], v[68:71], v[128:131]
    v_mfma_f32_16x16x32_bf16 v[132:135], v[212:215], v[68:71], v[132:135]
    s_add_u32 s69, s78, s101
    buffer_load_dwordx4 v[68:71], v3, s[40:43], s69 offen sc1
    s_waitcnt vmcnt(25)
    v_mfma_f32_16x16x32_bf16 v[136:139], v[196:199], v[72:75], v[136:139]
    v_mfma_f32_16x16x32_bf16 v[140:143], v[200:203], v[72:75], v[140:143]
    v_mfma_f32_16x16x32_bf16 v[144:147], v[204:207], v[72:75], v[144:147]
    v_mfma_f32_16x16x32_bf16 v[148:151], v[208:211], v[72:75], v[148:151]
    v_mfma_f32_16x16x32_bf16 v[152:155], v[212:215], v[72:75], v[152:155]
    s_add_u32 s69, s79, s101
    buffer_load_dwordx4 v[72:75], v3, s[40:43], s69 offen sc1
    s_add_u32 s101, s101, 1024
    s_cmp_eq_u32 s101, 14336
    s_cselect_b32 s101, 0, s101
    s_lshl_b32 s74, s59, 2
    s_add_u32 s74, s74, s57
    s_mul_i32 s74, s74, 20480
    s_add_u32 m0, s5, 40960
    s_waitcnt lgkmcnt(10)
    buffer_load_dwordx4 v6, s[44:47], s74 offen offset:0 lds
    buffer_load_dwordx4 v7, s[44:47], s74 offen offset:1024 lds
    buffer_load_dwordx4 v8, s[44:47], s74 offen offset:2048 lds
    s_waitcnt vmcnt(28)
    v_mfma_f32_16x16x32_bf16 v[76:79], v[216:219], v[12:15], v[76:79]
    s_waitcnt vmcnt(21)
    v_mfma_f32_16x16x32_bf16 v[80:83], v[220:223], v[12:15], v[80:83]
    ds_read_b64_tr_b16 v[196:197], v11 offset:0
    v_mfma_f32_16x16x32_bf16 v[84:87], v[224:227], v[12:15], v[84:87]
    ds_read_b64_tr_b16 v[198:199], v11 offset:1280
    v_mfma_f32_16x16x32_bf16 v[88:91], v[228:231], v[12:15], v[88:91]
    ds_read_b64_tr_b16 v[200:201], v11 offset:32
    v_mfma_f32_16x16x32_bf16 v[92:95], v[232:235], v[12:15], v[92:95]
    ds_read_b64_tr_b16 v[202:203], v11 offset:1312
    s_add_u32 s69, s7, s101
    buffer_load_dwordx4 v[12:15], v3, s[40:43], s69 offen sc1
    v_mfma_f32_16x16x32_bf16 v[96:99], v[216:219], v[16:19], v[96:99]
    ds_read_b64_tr_b16 v[204:205], v11 offset:64
    v_mfma_f32_16x16x32_bf16 v[100:103], v[220:223], v[16:19], v[100:103]
    ds_read_b64_tr_b16 v[206:207], v11 offset:1344
    v_mfma_f32_16x16x32_bf16 v[104:107], v[224:227], v[16:19], v[104:107]
    ds_read_b64_tr_b16 v[208:209], v11 offset:96
    v_mfma_f32_16x16x32_bf16 v[108:111], v[228:231], v[16:19], v[108:111]
    ds_read_b64_tr_b16 v[210:211], v11 offset:1376
    v_mfma_f32_16x16x32_bf16 v[112:115], v[232:235], v[16:19], v[112:115]
    ds_read_b64_tr_b16 v[212:213], v11 offset:128
    s_add_u32 s69, s77, s101
    buffer_load_dwordx4 v[16:19], v3, s[40:43], s69 offen sc1
    v_mfma_f32_16x16x32_bf16 v[116:119], v[216:219], v[20:23], v[116:119]
    ds_read_b64_tr_b16 v[214:215], v11 offset:1408
    v_mfma_f32_16x16x32_bf16 v[120:123], v[220:223], v[20:23], v[120:123]
    v_mfma_f32_16x16x32_bf16 v[124:127], v[224:227], v[20:23], v[124:127]
    v_mfma_f32_16x16x32_bf16 v[128:131], v[228:231], v[20:23], v[128:131]
    v_mfma_f32_16x16x32_bf16 v[132:135], v[232:235], v[20:23], v[132:135]
    s_add_u32 s69, s78, s101
    buffer_load_dwordx4 v[20:23], v3, s[40:43], s69 offen sc1
    s_waitcnt vmcnt(23)
    v_mfma_f32_16x16x32_bf16 v[136:139], v[216:219], v[24:27], v[136:139]
    v_mfma_f32_16x16x32_bf16 v[140:143], v[220:223], v[24:27], v[140:143]
    v_mfma_f32_16x16x32_bf16 v[144:147], v[224:227], v[24:27], v[144:147]
    v_mfma_f32_16x16x32_bf16 v[148:151], v[228:231], v[24:27], v[148:151]
    v_mfma_f32_16x16x32_bf16 v[152:155], v[232:235], v[24:27], v[152:155]
    s_add_u32 s69, s79, s101
    buffer_load_dwordx4 v[24:27], v3, s[40:43], s69 offen sc1
    s_add_u32 s101, s101, 1024
    s_cmp_eq_u32 s101, 14336
    s_cselect_b32 s101, 0, s101
    s_mul_i32 s73, s60, 320
    s_add_u32 s73, s73, 12288
    v_min_u32 v2, 39, v0
    v_lshlrev_b32 v2, 3, v2
    buffer_load_dwordx2 v[4:5], v2, s[40:43], s73 offen sc0 sc1
    s_waitcnt vmcnt(24)
    v_mfma_f32_16x16x32_bf16 v[76:79], v[236:239], v[28:31], v[76:79]
    s_waitcnt vmcnt(17)
    v_mfma_f32_16x16x32_bf16 v[80:83], v[240:243], v[28:31], v[80:83]
    ds_read_b64_tr_b16 v[216:217], v11 offset:20480
    v_mfma_f32_16x16x32_bf16 v[84:87], v[244:247], v[28:31], v[84:87]
    ds_read_b64_tr_b16 v[218:219], v11 offset:21760
    v_mfma_f32_16x16x32_bf16 v[88:91], v[248:251], v[28:31], v[88:91]
    ds_read_b64_tr_b16 v[220:221], v11 offset:20512
    v_mfma_f32_16x16x32_bf16 v[92:95], v[252:255], v[28:31], v[92:95]
    ds_read_b64_tr_b16 v[222:223], v11 offset:21792
    s_add_u32 s69, s7, s101
    buffer_load_dwordx4 v[28:31], v3, s[40:43], s69 offen sc1
    v_mfma_f32_16x16x32_bf16 v[96:99], v[236:239], v[32:35], v[96:99]
    ds_read_b64_tr_b16 v[224:225], v11 offset:20544
    v_mfma_f32_16x16x32_bf16 v[100:103], v[240:243], v[32:35], v[100:103]
    ds_read_b64_tr_b16 v[226:227], v11 offset:21824
    v_mfma_f32_16x16x32_bf16 v[104:107], v[244:247], v[32:35], v[104:107]
    ds_read_b64_tr_b16 v[228:229], v11 offset:20576
    v_mfma_f32_16x16x32_bf16 v[108:111], v[248:251], v[32:35], v[108:111]
    ds_read_b64_tr_b16 v[230:231], v11 offset:21856
    v_mfma_f32_16x16x32_bf16 v[112:115], v[252:255], v[32:35], v[112:115]
    ds_read_b64_tr_b16 v[232:233], v11 offset:20608
    s_add_u32 s69, s77, s101
    buffer_load_dwordx4 v[32:35], v3, s[40:43], s69 offen sc1
    v_mfma_f32_16x16x32_bf16 v[116:119], v[236:239], v[36:39], v[116:119]
    ds_read_b64_tr_b16 v[234:235], v11 offset:21888
    v_mfma_f32_16x16x32_bf16 v[120:123], v[240:243], v[36:39], v[120:123]
    v_mfma_f32_16x16x32_bf16 v[124:127], v[244:247], v[36:39], v[124:127]
    v_mfma_f32_16x16x32_bf16 v[128:131], v[248:251], v[36:39], v[128:131]
    v_mfma_f32_16x16x32_bf16 v[132:135], v[252:255], v[36:39], v[132:135]
    s_add_u32 s69, s78, s101
    buffer_load_dwordx4 v[36:39], v3, s[40:43], s69 offen sc1
    s_waitcnt vmcnt(19)
    v_mfma_f32_16x16x32_bf16 v[136:139], v[236:239], v[40:43], v[136:139]
    v_mfma_f32_16x16x32_bf16 v[140:143], v[240:243], v[40:43], v[140:143]
    v_mfma_f32_16x16x32_bf16 v[144:147], v[244:247], v[40:43], v[144:147]
    v_mfma_f32_16x16x32_bf16 v[148:151], v[248:251], v[40:43], v[148:151]
    v_mfma_f32_16x16x32_bf16 v[152:155], v[252:255], v[40:43], v[152:155]
    s_add_u32 s69, s79, s101
    buffer_load_dwordx4 v[40:43], v3, s[40:43], s69 offen sc1
    s_waitcnt vmcnt(19)
    v_mfma_f32_16x16x32_bf16 v[76:79], v[156:159], v[44:47], v[76:79]
    v_mfma_f32_16x16x32_bf16 v[80:83], v[160:163], v[44:47], v[80:83]
    v_mfma_f32_16x16x32_bf16 v[84:87], v[164:167], v[44:47], v[84:87]
    v_mfma_f32_16x16x32_bf16 v[88:91], v[168:171], v[44:47], v[88:91]
    v_mfma_f32_16x16x32_bf16 v[92:95], v[172:175], v[44:47], v[92:95]
    s_waitcnt vmcnt(18)
    v_mfma_f32_16x16x32_bf16 v[96:99], v[156:159], v[48:51], v[96:99]
    v_mfma_f32_16x16x32_bf16 v[100:103], v[160:163], v[48:51], v[100:103]
    v_mfma_f32_16x16x32_bf16 v[104:107], v[164:167], v[48:51], v[104:107]
    v_mfma_f32_16x16x32_bf16 v[108:111], v[168:171], v[48:51], v[108:111]
    v_mfma_f32_16x16x32_bf16 v[112:115], v[172:175], v[48:51], v[112:115]
    s_waitcnt vmcnt(17)
    v_mfma_f32_16x16x32_bf16 v[116:119], v[156:159], v[52:55], v[116:119]
    v_mfma_f32_16x16x32_bf16 v[120:123], v[160:163], v[52:55], v[120:123]
    v_mfma_f32_16x16x32_bf16 v[124:127], v[164:167], v[52:55], v[124:127]
    v_mfma_f32_16x16x32_bf16 v[128:131], v[168:171], v[52:55], v[128:131]
    v_mfma_f32_16x16x32_bf16 v[132:135], v[172:175], v[52:55], v[132:135]
    s_waitcnt vmcnt(16)
    v_mfma_f32_16x16x32_bf16 v[136:139], v[156:159], v[56:59], v[136:139]
    v_mfma_f32_16x16x32_bf16 v[140:143], v[160:163], v[56:59], v[140:143]
    v_mfma_f32_16x16x32_bf16 v[144:147], v[164:167], v[56:59], v[144:147]
    v_mfma_f32_16x16x32_bf16 v[148:151], v[168:171], v[56:59], v[148:151]
    v_mfma_f32_16x16x32_bf16 v[152:155], v[172:175], v[56:59], v[152:155]
    s_waitcnt vmcnt(4)
    v_xor_b32 v4, s66, v4
    v_xor_b32 v5, s66, v5
    v_or_b32 v4, v4, v5
    v_cmp_ne_u32 vcc, 0, v4
    s_cbranch_vccz L_yok_17
    s_mov_b32 s76, 262144
L_pollc_18:
    buffer_load_dwordx2 v[4:5], v2, s[40:43], s73 offen sc0 sc1
    s_waitcnt vmcnt(0)
    v_xor_b32 v4, s66, v4
    v_xor_b32 v5, s66, v5
    v_or_b32 v4, v4, v5
    v_cmp_ne_u32 vcc, 0, v4
    s_cbranch_vccz L_pollc_ok_19
    s_sub_u32 s76, s76, 1
    s_cmp_lg_u32 s76, 0
    s_cbranch_scc1 L_pollc_18
L_pollc_ok_19:
L_yok_17:
    s_mul_i32 s73, s60, 327680
    s_lshl_b32 s74, s59, 7
    s_add_u32 s73, s73, s74
    s_lshl_b32 s74, s57, 5
    s_add_u32 s73, s73, s74
    s_add_u32 s73, s73, 2711552
    v_lshrrev_b32 v4, 1, v0
    v_and_b32 v5, 1, v0
    v_lshlrev_b32 v5, 4, v5
    v_lshl_add_u32 v6, v4, 12, v5
    v_add_u32 v7, 130048, v6
    v_min_u32 v4, 15, v4
    v_lshl_add_u32 v4, v4, 12, v5
    v_add_u32 v4, 260096, v4
    s_add_u32 m0, s5, 61440
    s_waitcnt lgkmcnt(15)
    buffer_load_dwordx4 v6, s[40:43], s73 offen sc1 lds
    buffer_load_dwordx4 v7, s[40:43], s73 offen offset:1024 sc1 lds
    buffer_load_dwordx4 v4, s[40:43], s73 offen offset:2048 sc1 lds
    s_lshl_b32 s73, s59, 6
    s_lshl_b32 s74, s57, 4
    s_add_u32 s73, s73, s74
    v_and_b32 v4, 15, v0
    v_add_u32 v4, s73, v4
    v_lshlrev_b32 v6, 3, v4
    v_mul_u32_u24 v4, 1280, v4
    s_mul_i32 s73, s60, 160
    v_add_u32 v4, s73, v4
    v_lshrrev_b32 v8, 4, v0
    v_lshl_add_u32 v9, v8, 3, v4
    v_and_b32 v5, 15, v0
    v_mul_u32_u24 v5, 160, v5
    v_lshl_add_u32 v5, v8, 3, v5
    v_add_u32 v5, s5, v5
    ds_read_b64 v[236:237], v5 offset:40960
    ds_read_b64 v[238:239], v5 offset:40992
    ds_read_b64 v[240:241], v5 offset:41024
    ds_read_b64 v[242:243], v5 offset:41056
    ds_read_b64 v[244:245], v5 offset:41088
    v_lshl_add_u32 v10, v8, 3, v4
    v_and_b32 v5, 1, v8
    v_lshl_add_u32 v4, v5, 5, v4
    v_lshrrev_b32 v8, 1, v8
    v_lshl_add_u32 v2, v8, 4, v4
    v_bfe_u32 v8, v0, 2, 4
    v_lshlrev_b32 v8, 5, v8
    v_and_b32 v5, 3, v0
    v_lshl_add_u32 v8, v5, 3, v8
    v_add_u32 v8, s5, v8
    v_lshlrev_b32 v9, 4, v0
    v_add_u32 v7, s5, v9
    v_mfma_f32_16x16x32_bf16 v[76:79], v[176:179], v[60:63], v[76:79]
    v_mfma_f32_16x16x32_bf16 v[80:83], v[180:183], v[60:63], v[80:83]
    v_mfma_f32_16x16x32_bf16 v[84:87], v[184:187], v[60:63], v[84:87]
    v_mfma_f32_16x16x32_bf16 v[88:91], v[188:191], v[60:63], v[88:91]
    v_mfma_f32_16x16x32_bf16 v[92:95], v[192:195], v[60:63], v[92:95]
    v_mfma_f32_16x16x32_bf16 v[96:99], v[176:179], v[64:67], v[96:99]
    v_mfma_f32_16x16x32_bf16 v[100:103], v[180:183], v[64:67], v[100:103]
    v_mfma_f32_16x16x32_bf16 v[104:107], v[184:187], v[64:67], v[104:107]
    v_mfma_f32_16x16x32_bf16 v[108:111], v[188:191], v[64:67], v[108:111]
    v_mfma_f32_16x16x32_bf16 v[112:115], v[192:195], v[64:67], v[112:115]
    v_mfma_f32_16x16x32_bf16 v[116:119], v[176:179], v[68:71], v[116:119]
    v_mfma_f32_16x16x32_bf16 v[120:123], v[180:183], v[68:71], v[120:123]
    v_mfma_f32_16x16x32_bf16 v[124:127], v[184:187], v[68:71], v[124:127]
    v_mfma_f32_16x16x32_bf16 v[128:131], v[188:191], v[68:71], v[128:131]
    v_mfma_f32_16x16x32_bf16 v[132:135], v[192:195], v[68:71], v[132:135]
    v_mfma_f32_16x16x32_bf16 v[136:139], v[176:179], v[72:75], v[136:139]
    v_mfma_f32_16x16x32_bf16 v[140:143], v[180:183], v[72:75], v[140:143]
    v_mfma_f32_16x16x32_bf16 v[144:147], v[184:187], v[72:75], v[144:147]
    v_mfma_f32_16x16x32_bf16 v[148:151], v[188:191], v[72:75], v[148:151]
    v_mfma_f32_16x16x32_bf16 v[152:155], v[192:195], v[72:75], v[152:155]
    s_mov_b32 s74, 16388
    buffer_load_dword v72, v6, s[40:43], s74 offen sc1
    s_waitcnt lgkmcnt(15)
    v_mfma_f32_16x16x32_bf16 v[76:79], v[196:199], v[12:15], v[76:79]
    v_mfma_f32_16x16x32_bf16 v[80:83], v[200:203], v[12:15], v[80:83]
    v_mfma_f32_16x16x32_bf16 v[84:87], v[204:207], v[12:15], v[84:87]
    v_mfma_f32_16x16x32_bf16 v[88:91], v[208:211], v[12:15], v[88:91]
    s_waitcnt lgkmcnt(0)
    s_mov_b32 s73, 0xffff0000
    v_lshlrev_b32 v44, 16, v236
    v_mfma_f32_16x16x32_bf16 v[92:95], v[212:215], v[12:15], v[92:95]
    v_and_b32 v45, s73, v236
    v_lshlrev_b32 v46, 16, v237
    v_and_b32 v47, s73, v237
    v_mfma_f32_16x16x32_bf16 v[96:99], v[196:199], v[16:19], v[96:99]
    v_lshlrev_b32 v48, 16, v238
    v_and_b32 v49, s73, v238
    v_lshlrev_b32 v50, 16, v239
    v_mfma_f32_16x16x32_bf16 v[100:103], v[200:203], v[16:19], v[100:103]
    v_and_b32 v51, s73, v239
    v_lshlrev_b32 v52, 16, v240
    v_and_b32 v53, s73, v240
    v_mfma_f32_16x16x32_bf16 v[104:107], v[204:207], v[16:19], v[104:107]
    v_lshlrev_b32 v54, 16, v241
    v_and_b32 v55, s73, v241
    v_lshlrev_b32 v56, 16, v242
    v_mfma_f32_16x16x32_bf16 v[108:111], v[208:211], v[16:19], v[108:111]
    v_and_b32 v57, s73, v242
    v_lshlrev_b32 v58, 16, v243
    v_and_b32 v59, s73, v243
    v_mfma_f32_16x16x32_bf16 v[112:115], v[212:215], v[16:19], v[112:115]
    v_lshlrev_b32 v60, 16, v244
    v_and_b32 v61, s73, v244
    v_lshlrev_b32 v62, 16, v245
    v_mfma_f32_16x16x32_bf16 v[116:119], v[196:199], v[20:23], v[116:119]
    v_and_b32 v63, s73, v245
    v_mfma_f32_16x16x32_bf16 v[120:123], v[200:203], v[20:23], v[120:123]
    v_mfma_f32_16x16x32_bf16 v[124:127], v[204:207], v[20:23], v[124:127]
    v_mfma_f32_16x16x32_bf16 v[128:131], v[208:211], v[20:23], v[128:131]
    v_mfma_f32_16x16x32_bf16 v[132:135], v[212:215], v[20:23], v[132:135]
    v_mfma_f32_16x16x32_bf16 v[136:139], v[196:199], v[24:27], v[136:139]
    v_mfma_f32_16x16x32_bf16 v[140:143], v[200:203], v[24:27], v[140:143]
    v_mfma_f32_16x16x32_bf16 v[144:147], v[204:207], v[24:27], v[144:147]
    v_mfma_f32_16x16x32_bf16 v[148:151], v[208:211], v[24:27], v[148:151]
    v_mfma_f32_16x16x32_bf16 v[152:155], v[212:215], v[24:27], v[152:155]
    s_waitcnt vmcnt(1)
    ds_read_b64_tr_b16 v[246:247], v8 offset:61440
    ds_read_b64_tr_b16 v[248:249], v8 offset:61952
    ds_read_b64_tr_b16 v[250:251], v8 offset:62464
    ds_read_b64_tr_b16 v[252:253], v8 offset:62976
    ds_read_b64_tr_b16 v[254:255], v8 offset:63488
    v_mfma_f32_16x16x32_bf16 v[96:99], v[216:219], v[32:35], v[96:99]
    v_mfma_f32_16x16x32_bf16 v[100:103], v[220:223], v[32:35], v[100:103]
    v_mfma_f32_16x16x32_bf16 v[104:107], v[224:227], v[32:35], v[104:107]
    v_mfma_f32_16x16x32_bf16 v[108:111], v[228:231], v[32:35], v[108:111]
    s_waitcnt lgkmcnt(0)
    v_lshlrev_b32 v64, 16, v246
    v_and_b32 v65, s73, v246
    v_mfma_f32_16x16x32_bf16 v[112:115], v[232:235], v[32:35], v[112:115]
    v_lshlrev_b32 v66, 16, v247
    v_and_b32 v67, s73, v247
    v_add_f32 v44, v44, v64
    v_mfma_f32_16x16x32_bf16 v[116:119], v[216:219], v[36:39], v[116:119]
    v_add_f32 v45, v45, v65
    v_add_f32 v46, v46, v66
    v_add_f32 v47, v47, v67
    v_mfma_f32_16x16x32_bf16 v[120:123], v[220:223], v[36:39], v[120:123]
    v_lshlrev_b32 v68, 16, v248
    v_and_b32 v69, s73, v248
    v_lshlrev_b32 v70, 16, v249
    v_mfma_f32_16x16x32_bf16 v[124:127], v[224:227], v[36:39], v[124:127]
    v_and_b32 v71, s73, v249
    v_add_f32 v48, v48, v68
    v_add_f32 v49, v49, v69
    ds_write_b128 v7, v[96:99] offset:0
    v_mfma_f32_16x16x32_bf16 v[128:131], v[228:231], v[36:39], v[128:131]
    v_add_f32 v50, v50, v70
    v_add_f32 v51, v51, v71
    v_lshlrev_b32 v64, 16, v250
    ds_write_b128 v7, v[100:103] offset:1024
    ds_write_b128 v7, v[104:107] offset:2048
    v_mfma_f32_16x16x32_bf16 v[132:135], v[232:235], v[36:39], v[132:135]
    v_and_b32 v65, s73, v250
    v_lshlrev_b32 v66, 16, v251
    v_and_b32 v67, s73, v251
    ds_write_b128 v7, v[108:111] offset:3072
    ds_write_b128 v7, v[112:115] offset:4096
    v_mfma_f32_16x16x32_bf16 v[136:139], v[216:219], v[40:43], v[136:139]
    v_add_f32 v52, v52, v64
    v_add_f32 v53, v53, v65
    v_add_f32 v54, v54, v66
    v_mfma_f32_16x16x32_bf16 v[140:143], v[220:223], v[40:43], v[140:143]
    v_add_f32 v55, v55, v67
    v_lshlrev_b32 v68, 16, v252
    v_and_b32 v69, s73, v252
    v_mfma_f32_16x16x32_bf16 v[144:147], v[224:227], v[40:43], v[144:147]
    v_lshlrev_b32 v70, 16, v253
    v_and_b32 v71, s73, v253
    v_add_f32 v56, v56, v68
    ds_write_b128 v7, v[116:119] offset:20480
    v_mfma_f32_16x16x32_bf16 v[148:151], v[228:231], v[40:43], v[148:151]
    v_add_f32 v57, v57, v69
    v_add_f32 v58, v58, v70
    v_add_f32 v59, v59, v71
    ds_write_b128 v7, v[120:123] offset:21504
    ds_write_b128 v7, v[124:127] offset:22528
    v_mfma_f32_16x16x32_bf16 v[152:155], v[232:235], v[40:43], v[152:155]
    v_lshlrev_b32 v64, 16, v254
    v_and_b32 v65, s73, v254
    v_lshlrev_b32 v66, 16, v255
    ds_write_b128 v7, v[128:131] offset:23552
    ds_write_b128 v7, v[132:135] offset:24576
    v_mfma_f32_16x16x32_bf16 v[76:79], v[216:219], v[28:31], v[76:79]
    v_and_b32 v67, s73, v255
    v_add_f32 v60, v60, v64
    v_add_f32 v61, v61, v65
    v_mfma_f32_16x16x32_bf16 v[80:83], v[220:223], v[28:31], v[80:83]
    v_add_f32 v62, v62, v66
    v_add_f32 v63, v63, v67
    v_mfma_f32_16x16x32_bf16 v[84:87], v[224:227], v[28:31], v[84:87]
    ds_write_b128 v7, v[136:139] offset:40960
    v_mfma_f32_16x16x32_bf16 v[88:91], v[228:231], v[28:31], v[88:91]
    ds_write_b128 v7, v[140:143] offset:41984
    ds_write_b128 v7, v[144:147] offset:43008
    v_mfma_f32_16x16x32_bf16 v[92:95], v[232:235], v[28:31], v[92:95]
    ds_write_b128 v7, v[148:151] offset:44032
    ds_write_b128 v7, v[152:155] offset:45056
    s_sub_u32 s73, s57, 1
    s_and_b32 s73, s73, 3
    s_mul_i32 s73, s73, 5120
    v_add_u32 v4, s73, v9
    s_sub_u32 s73, s57, 2
    s_and_b32 s73, s73, 3
    s_mul_i32 s73, s73, 5120
    v_add_u32 v5, s73, v9
    s_sub_u32 s73, s57, 3
    s_and_b32 s73, s73, 3
    s_mul_i32 s73, s73, 5120
    v_add_u32 v6, s73, v9
    s_waitcnt lgkmcnt(0)
    s_barrier
    ds_read_b128 v[156:159], v4 offset:0
    ds_read_b128 v[176:179], v5 offset:20480
    ds_read_b128 v[196:199], v6 offset:40960
    ds_read_b128 v[160:163], v4 offset:1024
    ds_read_b128 v[180:183], v5 offset:21504
    ds_read_b128 v[200:203], v6 offset:41984
    ds_read_b128 v[164:167], v4 offset:2048
    ds_read_b128 v[184:187], v5 offset:22528
    ds_read_b128 v[204:207], v6 offset:43008
    ds_read_b128 v[168:171], v4 offset:3072
    ds_read_b128 v[188:191], v5 offset:23552
    ds_read_b128 v[208:211], v6 offset:44032
    ds_read_b128 v[172:175], v4 offset:4096
    ds_read_b128 v[192:195], v5 offset:24576
    ds_read_b128 v[212:215], v6 offset:45056
    s_waitcnt vmcnt(0)
    s_waitcnt lgkmcnt(12)
    v_pk_add_f32 v[156:157], v[156:157], v[176:177]
    v_pk_add_f32 v[158:159], v[158:159], v[178:179]
    v_pk_add_f32 v[76:77], v[76:77], v[196:197]
    v_pk_add_f32 v[78:79], v[78:79], v[198:199]
    v_pk_add_f32 v[76:77], v[76:77], v[156:157]
    v_pk_add_f32 v[78:79], v[78:79], v[158:159]
    v_fmac_f32 v44, v72, v76
    v_fmac_f32 v45, v72, v77
    v_fmac_f32 v46, v72, v78
    v_fmac_f32 v47, v72, v79
    v_cvt_pk_bf16_f32 v216, v44, v45
    v_cvt_pk_bf16_f32 v217, v46, v47
    s_waitcnt lgkmcnt(9)
    v_pk_add_f32 v[160:161], v[160:161], v[180:181]
    v_pk_add_f32 v[162:163], v[162:163], v[182:183]
    v_pk_add_f32 v[80:81], v[80:81], v[200:201]
    v_pk_add_f32 v[82:83], v[82:83], v[202:203]
    v_pk_add_f32 v[80:81], v[80:81], v[160:161]
    v_pk_add_f32 v[82:83], v[82:83], v[162:163]
    v_fmac_f32 v48, v72, v80
    v_fmac_f32 v49, v72, v81
    v_fmac_f32 v50, v72, v82
    v_fmac_f32 v51, v72, v83
    v_cvt_pk_bf16_f32 v218, v48, v49
    v_cvt_pk_bf16_f32 v219, v50, v51
    s_nop 0
    v_permlane16_swap_b32 v216, v218
    v_permlane16_swap_b32 v217, v219
    buffer_store_dwordx4 v[216:219], v2, s[52:55], 0 offen offset:0
    s_waitcnt lgkmcnt(6)
    v_pk_add_f32 v[164:165], v[164:165], v[184:185]
    v_pk_add_f32 v[166:167], v[166:167], v[186:187]
    v_pk_add_f32 v[84:85], v[84:85], v[204:205]
    v_pk_add_f32 v[86:87], v[86:87], v[206:207]
    v_pk_add_f32 v[84:85], v[84:85], v[164:165]
    v_pk_add_f32 v[86:87], v[86:87], v[166:167]
    v_fmac_f32 v52, v72, v84
    v_fmac_f32 v53, v72, v85
    v_fmac_f32 v54, v72, v86
    v_fmac_f32 v55, v72, v87
    v_cvt_pk_bf16_f32 v220, v52, v53
    v_cvt_pk_bf16_f32 v221, v54, v55
    s_waitcnt lgkmcnt(3)
    v_pk_add_f32 v[168:169], v[168:169], v[188:189]
    v_pk_add_f32 v[170:171], v[170:171], v[190:191]
    v_pk_add_f32 v[88:89], v[88:89], v[208:209]
    v_pk_add_f32 v[90:91], v[90:91], v[210:211]
    v_pk_add_f32 v[88:89], v[88:89], v[168:169]
    v_pk_add_f32 v[90:91], v[90:91], v[170:171]
    v_fmac_f32 v56, v72, v88
    v_fmac_f32 v57, v72, v89
    v_fmac_f32 v58, v72, v90
    v_fmac_f32 v59, v72, v91
    v_cvt_pk_bf16_f32 v222, v56, v57
    v_cvt_pk_bf16_f32 v223, v58, v59
    s_nop 0
    v_permlane16_swap_b32 v220, v222
    v_permlane16_swap_b32 v221, v223
    buffer_store_dwordx4 v[220:223], v2, s[52:55], 0 offen offset:64
    s_waitcnt lgkmcnt(0)
    v_pk_add_f32 v[172:173], v[172:173], v[192:193]
    v_pk_add_f32 v[174:175], v[174:175], v[194:195]
    v_pk_add_f32 v[92:93], v[92:93], v[212:213]
    v_pk_add_f32 v[94:95], v[94:95], v[214:215]
    v_pk_add_f32 v[92:93], v[92:93], v[172:173]
    v_pk_add_f32 v[94:95], v[94:95], v[174:175]
    v_fmac_f32 v60, v72, v92
    v_fmac_f32 v61, v72, v93
    v_fmac_f32 v62, v72, v94
    v_fmac_f32 v63, v72, v95
    v_cvt_pk_bf16_f32 v224, v60, v61
    v_cvt_pk_bf16_f32 v225, v62, v63
    buffer_store_dwordx2 v[224:225], v10, s[52:55], 0 offen offset:128
    s_endpgm
L_exit:
    s_endpgm
.section .rodata,"a"
.p2align 6
.amdhsa_kernel parallel_sum__ssm_conv_s4__glu_gated_reglu__prompt_kernel
  .amdhsa_next_free_vgpr 256
  .amdhsa_next_free_sgpr 102
  .amdhsa_accum_offset 256
  .amdhsa_group_segment_fixed_size 0
  .amdhsa_kernarg_size 128
  .amdhsa_user_sgpr_count 2
  .amdhsa_user_sgpr_kernarg_segment_ptr 1
  .amdhsa_system_sgpr_workgroup_id_x 1
  .amdhsa_float_denorm_mode_32 3
.end_amdhsa_kernel
```
